```python
import torch

def _softmax(x, axis=-1):
    return torch.softmax(x, dim=axis)
def _gelu(x):
    return torch.nn.functional.gelu(x, approximate="tanh")
def _silu(x):
    return torch.nn.functional.silu(x)
def _sigmoid(x):
    return torch.sigmoid(x)
def _layernorm(x, axis=-1, eps=1e-5):
    m = x.mean(dim=axis, keepdim=True)
    v = x.var(dim=axis, keepdim=True, unbiased=False)
    return (x - m) / torch.sqrt(v + eps)
def _scatter_add(tgt, idx, src, axis=0):
    return tgt.clone().index_add_(axis, idx, src)
def _segment_sum(src, seg, n):
    out = torch.zeros((n,) + src.shape[1:], dtype=src.dtype)
    return out.index_add_(0, seg, src)
def _pad(x, pw):
    flat = tuple(v for pair in reversed(pw) for v in pair)
    return torch.nn.functional.pad(x, flat)

kernel_name = 'gated_mix__ssm_conv_s4__glu_gated_bilinear__prompt'

def setup_inputs():

    _w = (lambda a: (lambda t: t.to(torch.bfloat16) if t.is_floating_point() else t)(torch.as_tensor(a)))
    def _A_setup():
        B, L, D, N = 1, 2048, 640, 128
        A_re = -(lambda _x: torch.exp(torch.as_tensor(_x)))((lambda *s: torch.randn(*s, dtype=torch.bfloat16) * 3.2)(D, N))
        A_im = torch.pi * (lambda *s: torch.randn(*s, dtype=torch.bfloat16) * 0.05)(D, N)
        B_re = (lambda *s: torch.randn(*s, dtype=torch.bfloat16) * 0.1)(D, N)
        B_im = (lambda *s: torch.randn(*s, dtype=torch.bfloat16) * 0.1)(D, N)
        C_re = (lambda *s: torch.randn(*s, dtype=torch.bfloat16) * 0.1)(D, N)
        C_im = (lambda *s: torch.randn(*s, dtype=torch.bfloat16) * 0.1)(D, N)
        log_dt = (lambda *s: torch.randn(*s, dtype=torch.bfloat16) * 0.05)(D) * 0.5 - 4.0
        Dskip = (lambda *s: torch.randn(*s, dtype=torch.bfloat16) * 0.05)(D)
        return {
            "u": _w((lambda *s: torch.randn(*s, dtype=torch.bfloat16) * 0.05)(B, L, D)),
            "A_re": _w(A_re),
            "A_im": _w(A_im),
            "B_re": _w(B_re),
            "B_im": _w(B_im),
            "C_re": _w(C_re),
            "C_im": _w(C_im),
            "log_dt": _w(log_dt),
            "Dskip": _w(Dskip),
        }
    _A_in = _A_setup()

    def _B_setup():
        B, S, D, F = 1, 2048, 640, 1728
        return {
            "x": _w((lambda *s: torch.randn(*s, dtype=torch.bfloat16) * 0.05)(B, S, D)),
            "w_gate": _w((lambda *s: torch.randn(*s, dtype=torch.bfloat16) * 0.8)(D, F) * (D ** -0.5)),
            "w_up": _w((lambda *s: torch.randn(*s, dtype=torch.bfloat16) * 0.8)(D, F) * (D ** -0.5)),
            "w_down": _w((lambda *s: torch.randn(*s, dtype=torch.bfloat16) * 0.8)(F, D) * (F ** -0.5)),
        }
    _B_in = _B_setup()

    return {
        "A_u": _A_in["u"],
        "A_A_re": _A_in["A_re"],
        "A_A_im": _A_in["A_im"],
        "A_B_re": _A_in["B_re"],
        "A_B_im": _A_in["B_im"],
        "A_C_re": _A_in["C_re"],
        "A_C_im": _A_in["C_im"],
        "A_log_dt": _A_in["log_dt"],
        "A_Dskip": _A_in["Dskip"],
        "B_x": _B_in["x"],
        "B_w_gate": _B_in["w_gate"],
        "B_w_up": _B_in["w_up"],
        "B_w_down": _B_in["w_down"],
        "gate_w": _w((lambda *s: torch.randn(*s, dtype=torch.bfloat16) * 0.05)(640) * 16.0),
    }

def reference(A_u, A_A_re, A_A_im, A_B_re, A_B_im, A_C_re, A_C_im, A_log_dt, A_Dskip, B_x, B_w_gate, B_w_up, B_w_down, gate_w):
    def _A_ref(u, A_re, A_im, B_re, B_im, C_re, C_im, log_dt, Dskip):
        Bsz, L, D = u.shape
        dt = torch.exp(log_dt)[:, None]
        A = A_re + 1j * A_im
        Bc = B_re + 1j * B_im
        Cc = C_re + 1j * C_im
        logdA = dt * A
        dB = dt * Bc
        l = (lambda x, dt: x.to(dt))(torch.arange(L), A_re.dtype)
        P = torch.exp(logdA[:, :, None] * l[None, None, :])
        K = torch.einsum("dn,dnl,dn->dl", Cc, P, dB).real
        L2 = 2 * L
        Kp = _pad(K, ((0, 0), (0, L)))
        up = (lambda x, *d: x.permute(*d))(u, 0, 2, 1)
        up = _pad(up, ((0, 0), (0, 0), (0, L)))
        Kf = (lambda x, axes=(-2,-1): torch.fft.rfft2(x.float(), dim=axes))(Kp[:, None, :], axes=(-2, -1))
        Uf = (lambda x, axes=(-2,-1): torch.fft.rfft2(x.float(), dim=axes))(up[:, :, None, :], axes=(-2, -1))
        Yf = Uf * Kf[None, :, :, :]
        y = (lambda x, s, axes=(-2,-1): torch.fft.irfft2(x, s=s, dim=axes).to(torch.bfloat16))(Yf, (1, L2), axes=(-2, -1))[:, :, 0, :L]
        y = (lambda x, *d: x.permute(*d))(y, 0, 2, 1) + u * Dskip[None, None, :]
        return y

    def _B_ref(x, w_gate, w_up, w_down):
        g = torch.einsum("bsd,df->bsf", x, w_gate)
        u = torch.einsum("bsd,df->bsf", x, w_up)
        h = g * u
        return torch.einsum("bsf,fd->bsd", h, w_down)

    x = A_u
    g = _sigmoid((x * gate_w).sum(-1, keepdims=True))
    a = _A_ref(x, A_A_re, A_A_im, A_B_re, A_B_im, A_C_re, A_C_im, A_log_dt, A_Dskip)
    b = _B_ref(x, B_w_gate, B_w_up, B_w_down)
    return g * a + (1 - g) * b
```

```asm
; @launch grid=(256,1,1) block=(512,1,1) lds=163840
.amdgcn_target "amdgcn-amd-amdhsa--gfx950"
.text
.globl gated_mix__ssm_conv_s4__glu_gated_bilinear__prompt_kernel
.p2align 8
.type gated_mix__ssm_conv_s4__glu_gated_bilinear__prompt_kernel,@function
gated_mix__ssm_conv_s4__glu_gated_bilinear__prompt_kernel:
    s_cmp_ge_u32 s2, 256
    s_cbranch_scc1 the_end
    s_load_dwordx16 s[16:31], s[0:1], 0
    s_load_dwordx16 s[32:47], s[0:1], 64
    s_load_dwordx2 s[48:49], s[0:1], 128
    v_lshrrev_b32 v2, 6, v0
    v_and_b32 v1, 63, v0
    v_readfirstlane_b32 s6, v2
    s_lshr_b32 s11, s2, 3
    s_and_b32 s10, s2, 7
    s_cmp_ge_u32 s11, 27
    s_cselect_b32 s3, 0, s6
    s_cmp_ge_u32 s3, 6
    s_cbranch_scc1 loader
    s_cmp_ge_u32 s3, 4
    s_cbranch_scc1 not_ld
    s_sub_u32 s3, s11, 25
    s_cmp_lt_u32 s3, 2
    s_cbranch_scc1 walk_go
    s_lshr_b32 s50, s6, 1
    s_lshl1_add_u32 s4, s11, 30
    s_cmp_lt_u32 s11, 27
    s_cbranch_scc1 ch_j
    s_cmp_ge_u32 s6, 6
    s_cselect_b32 s4, 2, 0
    s_sub_u32 s50, s6, s4
    s_mul_i32 s4, s3, 6
    s_sub_u32 s4, s4, 12
ch_j:
    s_mul_i32 s3, s10, 80
    s_add_u32 s4, s4, s50
    s_add_u32 s68, s4, s3
    s_lshl_b32 s3, s68, 8
    v_lshl_add_u32 v96, v1, 2, s3
    s_lshl_b32 s3, s68, 1
    v_mov_b32 v97, s3
    s_waitcnt lgkmcnt(0)
    global_load_ushort v246, v97, s[30:31]
    global_load_dword v240, v96, s[18:19]
    global_load_dword v241, v96, s[20:21]
    global_load_dword v242, v96, s[22:23]
    global_load_dword v243, v96, s[24:25]
    global_load_dword v244, v96, s[26:27]
    global_load_dword v245, v96, s[28:29]
    s_branch kg_in
walk_go:
    s_lshl2_add_u32 s3, s3, s6
    s_mov_b64 exec, 0
    s_cmp_eq_u32 s3, 0
    s_cbranch_scc1 walk_0
    s_cmp_eq_u32 s3, 1
    s_cbranch_scc1 walk_1
    s_cmp_eq_u32 s3, 2
    s_cbranch_scc1 walk_2
    s_cmp_eq_u32 s3, 3
    s_cbranch_scc1 walk_3
    s_branch walk_far
loader:
    s_lshr_b32 s3, s10, 1
    s_mul_i32 s3, s3, 27
    s_add_u32 s3, s3, s11
    s_lshr_b32 s8, s3, 2
    s_and_b32 s3, s3, 3
    s_and_b32 s4, s10, 1
    s_lshl2_add_u32 s7, s4, s3
    s_and_b32 s3, s7, 3
    s_lshl_b32 s3, s3, 2
    s_lshr_b32 s3, 0x3210, s3
    s_and_b32 s3, s3, 15
    s_and_b32 s4, s8, -2
    s_cmp_ge_u32 s8, 10
    s_addc_u32 s3, s3, s4
    s_mul_i32 s4, s3, 205
    s_lshr_b32 s4, s4, 11
    s_mul_i32 s4, s4, 10
    s_sub_u32 s9, s3, s4
    s_and_b32 s81, s6, 1
    v_lshrrev_b32 v20, 3, v1
    v_and_b32 v21, 2, v20
    v_xor_b32 v21, v21, v1
    v_and_b32 v21, 7, v21
    v_mul_u32_u24 v22, 3456, v20
    s_lshl_b32 s3, s8, 7
    v_add_u32 v22, s3, v22
    v_lshl_add_u32 v12, v21, 4, v22
    v_xor_b32 v23, 64, v12
    s_mul_i32 s77, s9, 221184
    s_lshl_b32 s78, s81, 13
    s_add_u32 s68, s78, 65536
    s_mov_b32 s69, s78
    s_lshl_b32 s76, s9, 7
    s_mov_b32 s58, 0x21c000
    s_mov_b32 s59, 0x20000
    s_cmp_eq_u32 s81, 1
    s_waitcnt lgkmcnt(0)
    s_cselect_b64 s[56:57], s[38:39], s[36:37]
ld_first:
    s_mov_b32 m0, s68
    v_add_u32 v13, 26624, v23
    buffer_load_dwordx4 v12, s[56:59], s77 offen offset:0 lds
    v_add_u32 v14, 53248, v12
    buffer_load_dwordx4 v13, s[56:59], s77 offen offset:1024 lds
    v_add_u32 v15, 79872, v23
    buffer_load_dwordx4 v14, s[56:59], s77 offen offset:2048 lds
    v_add_u32 v16, 110592, v12
    buffer_load_dwordx4 v15, s[56:59], s77 offen offset:3072 lds
    s_add_u32 m0, s68, 4096
    v_add_u32 v17, 137216, v23
    buffer_load_dwordx4 v16, s[56:59], s77 offen offset:0 lds
    v_add_u32 v18, 163840, v12
    buffer_load_dwordx4 v17, s[56:59], s77 offen offset:1024 lds
    v_add_u32 v19, 190464, v23
    buffer_load_dwordx4 v18, s[56:59], s77 offen offset:2048 lds
    buffer_load_dwordx4 v19, s[56:59], s77 offen offset:3072 lds
    v_lshrrev_b32 v21, 4, v1
    v_xor_b32 v21, v21, v1
    v_and_b32 v21, 7, v21
    s_lshl1_add_u32 s3, s7, s81
    s_mul_i32 s3, s3, 163840
    v_mul_u32_u24 v22, 1280, v20
    v_add_u32 v22, s3, v22
    v_lshl_add_u32 v4, v21, 4, v22
    v_xor_b32 v24, 64, v4
    s_mov_b32 s52, s16
    s_mov_b32 s53, s17
    s_mov_b32 s54, 0x280000
    s_mov_b32 s55, 0x20000
    s_mov_b32 m0, s69
    v_add_u32 v5, 9216, v24
    buffer_load_dwordx4 v4, s[52:55], s76 offen offset:0 lds
    v_add_u32 v6, 18432, v4
    buffer_load_dwordx4 v5, s[52:55], s76 offen offset:1024 lds
    v_add_u32 v7, 27648, v24
    buffer_load_dwordx4 v6, s[52:55], s76 offen offset:2048 lds
    v_add_u32 v8, 40960, v4
    buffer_load_dwordx4 v7, s[52:55], s76 offen offset:3072 lds
    s_add_u32 m0, s69, 4096
    v_add_u32 v9, 50176, v24
    buffer_load_dwordx4 v8, s[52:55], s76 offen offset:0 lds
    v_add_u32 v10, 59392, v4
    buffer_load_dwordx4 v9, s[52:55], s76 offen offset:1024 lds
walk_3:
pad_ld_0:
    s_cbranch_execz pad_ld_1
    v_add_u32 v11, 68608, v24
    buffer_load_dwordx4 v10, s[52:55], s76 offen offset:2048 lds
    buffer_load_dwordx4 v11, s[52:55], s76 offen offset:3072 lds
    s_add_u32 s79, s76, 81920
    s_add_u32 m0, s69, 16384
    s_add_u32 s77, s77, 221184
    buffer_load_dwordx4 v4, s[52:55], s79 offen offset:0 lds
    buffer_load_dwordx4 v5, s[52:55], s79 offen offset:1024 lds
    buffer_load_dwordx4 v6, s[52:55], s79 offen offset:2048 lds
    buffer_load_dwordx4 v7, s[52:55], s79 offen offset:3072 lds
    s_add_u32 m0, s69, 20480
    s_add_u32 s76, s76, 128
    buffer_load_dwordx4 v8, s[52:55], s79 offen offset:0 lds
    buffer_load_dwordx4 v9, s[52:55], s79 offen offset:1024 lds
    buffer_load_dwordx4 v10, s[52:55], s79 offen offset:2048 lds
    buffer_load_dwordx4 v11, s[52:55], s79 offen offset:3072 lds
    s_cmp_eq_u32 s76, 1280
    s_cselect_b32 s76, 0, s76
    s_cselect_b32 s77, 0, s77
    s_add_u32 s68, s68, 16384
    s_add_u32 s69, s69, 32768
    s_bitcmp1_b32 s69, 15
    s_cbranch_scc1 ld_first
    v_lshrrev_b32 v2, 8, v0
    v_lshlrev_b32 v0, 2, v0
    v_add_u32 v0, 161792, v0
    v_xor_b32 v2, 1, v2
    ds_write_b32 v0, v2
    s_and_b32 s3, s11, 3
    s_and_b32 s4, s10, 1
    s_lshl2_add_u32 s14, s4, s3
    s_lshr_b32 s3, s11, 2
    s_lshr_b32 s4, s10, 1
    s_lshl3_add_u32 s13, s4, s3
    s_mov_b32 s12, 65536
    s_mov_b32 s100, 0
    s_lshl_b32 s3, s14, 5
    s_add_u32 s3, s3, s13
    s_lshl_b32 s3, s3, 7
    s_add_u32 s51, s3, 0xa48000
pad_ld_1:
    s_cbranch_execz pad_ll_0
    s_mov_b32 s75, 141312
    s_cmp_ge_u32 s11, 27
    s_cselect_b32 s15, 1, 0
    s_cselect_b32 s75, 116864, s75
    s_mov_b32 s60, s48
    s_mov_b32 s61, s49
    s_mov_b32 s62, 0x1a00000
    s_mov_b32 s63, 0x20000
    s_mov_b32 s64, s44
    s_mov_b32 s65, s45
    s_mov_b32 s66, 0x280000
    s_mov_b32 s67, 0x20000
    s_mov_b32 s80, 4
    v_lshlrev_b32 v20, 4, v1
    v_lshrrev_b32 v21, 2, v1
    v_mul_u32_u24 v21, 40960, v21
    v_and_b32 v22, 3, v1
    v_lshl_add_u32 v21, v22, 4, v21
    s_waitcnt vmcnt(32) lgkmcnt(0)
    s_barrier
ld_loop:
pad_ll_0:
    s_cbranch_execz pad_ll_1
    s_waitcnt vmcnt(16)
    s_barrier
    s_add_u32 m0, s78, 65536
    s_nop 0
    buffer_load_dwordx4 v12, s[56:59], s77 offen offset:0 lds
    buffer_load_dwordx4 v13, s[56:59], s77 offen offset:1024 lds
    buffer_load_dwordx4 v14, s[56:59], s77 offen offset:2048 lds
    buffer_load_dwordx4 v15, s[56:59], s77 offen offset:3072 lds
    s_add_u32 m0, s78, 69632
    s_nop 0
    buffer_load_dwordx4 v16, s[56:59], s77 offen offset:0 lds
    buffer_load_dwordx4 v17, s[56:59], s77 offen offset:1024 lds
    buffer_load_dwordx4 v18, s[56:59], s77 offen offset:2048 lds
    buffer_load_dwordx4 v19, s[56:59], s77 offen offset:3072 lds
    s_add_u32 s77, s77, 221184
    s_cmp_eq_u32 s77, 2211840
    s_cselect_b32 s77, 0, s77
    s_add_u32 m0, s78, 0
    s_nop 0
    buffer_load_dwordx4 v4, s[52:55], s76 offen offset:0 lds
    buffer_load_dwordx4 v5, s[52:55], s76 offen offset:1024 lds
pad_ll_1:
    s_cbranch_execz pad_ll_2
    buffer_load_dwordx4 v6, s[52:55], s76 offen offset:2048 lds
    buffer_load_dwordx4 v7, s[52:55], s76 offen offset:3072 lds
    s_add_u32 m0, s78, 4096
    s_nop 0
    buffer_load_dwordx4 v8, s[52:55], s76 offen offset:0 lds
    buffer_load_dwordx4 v9, s[52:55], s76 offen offset:1024 lds
    buffer_load_dwordx4 v10, s[52:55], s76 offen offset:2048 lds
    buffer_load_dwordx4 v11, s[52:55], s76 offen offset:3072 lds
    s_waitcnt vmcnt(24)
    s_barrier
    s_add_u32 s79, s76, 81920
    s_add_u32 m0, s78, 16384
    s_nop 0
    buffer_load_dwordx4 v4, s[52:55], s79 offen offset:0 lds
    buffer_load_dwordx4 v5, s[52:55], s79 offen offset:1024 lds
    buffer_load_dwordx4 v6, s[52:55], s79 offen offset:2048 lds
    buffer_load_dwordx4 v7, s[52:55], s79 offen offset:3072 lds
    s_add_u32 m0, s78, 20480
    s_nop 0
    buffer_load_dwordx4 v8, s[52:55], s79 offen offset:0 lds
    buffer_load_dwordx4 v9, s[52:55], s79 offen offset:1024 lds
    buffer_load_dwordx4 v10, s[52:55], s79 offen offset:2048 lds
    buffer_load_dwordx4 v11, s[52:55], s79 offen offset:3072 lds
    s_add_u32 s76, s76, 128
    s_cmp_eq_u32 s76, 1280
    s_cselect_b32 s76, 0, s76
    s_waitcnt vmcnt(16)
    s_barrier
    s_add_u32 m0, s78, 81920
    s_nop 0
    buffer_load_dwordx4 v12, s[56:59], s77 offen offset:0 lds
    buffer_load_dwordx4 v13, s[56:59], s77 offen offset:1024 lds
    buffer_load_dwordx4 v14, s[56:59], s77 offen offset:2048 lds
    buffer_load_dwordx4 v15, s[56:59], s77 offen offset:3072 lds
    s_add_u32 m0, s78, 86016
    s_nop 0
pad_ll_2:
    s_cbranch_execz pad_ll_3
    buffer_load_dwordx4 v16, s[56:59], s77 offen offset:0 lds
    buffer_load_dwordx4 v17, s[56:59], s77 offen offset:1024 lds
    buffer_load_dwordx4 v18, s[56:59], s77 offen offset:2048 lds
    buffer_load_dwordx4 v19, s[56:59], s77 offen offset:3072 lds
    s_add_u32 s77, s77, 221184
    s_cmp_eq_u32 s77, 2211840
    s_cselect_b32 s77, 0, s77
    s_add_u32 m0, s78, 32768
    s_nop 0
    buffer_load_dwordx4 v4, s[52:55], s76 offen offset:0 lds
    buffer_load_dwordx4 v5, s[52:55], s76 offen offset:1024 lds
    buffer_load_dwordx4 v6, s[52:55], s76 offen offset:2048 lds
    buffer_load_dwordx4 v7, s[52:55], s76 offen offset:3072 lds
    s_add_u32 m0, s78, 36864
    s_nop 0
    buffer_load_dwordx4 v8, s[52:55], s76 offen offset:0 lds
    buffer_load_dwordx4 v9, s[52:55], s76 offen offset:1024 lds
    buffer_load_dwordx4 v10, s[52:55], s76 offen offset:2048 lds
    buffer_load_dwordx4 v11, s[52:55], s76 offen offset:3072 lds
    s_waitcnt vmcnt(24)
    s_barrier
    s_add_u32 s79, s76, 81920
    s_add_u32 m0, s78, 49152
    s_nop 0
    buffer_load_dwordx4 v4, s[52:55], s79 offen offset:0 lds
    buffer_load_dwordx4 v5, s[52:55], s79 offen offset:1024 lds
    buffer_load_dwordx4 v6, s[52:55], s79 offen offset:2048 lds
    buffer_load_dwordx4 v7, s[52:55], s79 offen offset:3072 lds
    s_add_u32 m0, s78, 53248
    s_nop 0
    buffer_load_dwordx4 v8, s[52:55], s79 offen offset:0 lds
    buffer_load_dwordx4 v9, s[52:55], s79 offen offset:1024 lds
    buffer_load_dwordx4 v10, s[52:55], s79 offen offset:2048 lds
    buffer_load_dwordx4 v11, s[52:55], s79 offen offset:3072 lds
    s_add_u32 s76, s76, 128
pad_ll_3:
    s_cbranch_execz pad_ll_4
    s_cmp_eq_u32 s76, 1280
    s_cselect_b32 s76, 0, s76
    s_sub_u32 s80, s80, 1
    s_cmp_lg_u32 s80, 0
    s_cbranch_scc1 ld_loop
    s_lshl2_add_u32 m0, s81, 161824
    s_mov_b64 exec, 1
    buffer_load_dword v4, s[52:55], s54 offen offset:0 lds
    s_mov_b64 exec, -1
    s_and_b32 s3, s6, 3
    s_lshl2_add_u32 s3, s14, s3
    s_lshl_b32 s3, s3, 7
    s_add_u32 s3, s3, 0xa52800
    s_buffer_load_dwordx16 s[16:31], s[60:63], s3 glc
    s_buffer_load_dwordx4 s[32:35], s[60:63], s51 glc
    s_waitcnt vmcnt(17)
    s_barrier
    s_cmp_ge_u32 s11, 25
    s_cbranch_scc1 g2pre
    s_lshl1_add_u32 s5, s11, s81
    s_mul_i32 s3, s10, 80
    s_add_u32 s3, s3, s5
    s_lshl_b32 s3, s3, 6
    s_add_u32 s77, s3, 0xc00780
    s_waitcnt lgkmcnt(0)
    s_cmp_eq_u32 s32, 1
    s_cbranch_scc1 ld_uok
pw_1:
    s_buffer_load_dwordx4 s[32:35], s[60:63], s51 glc
    s_waitcnt lgkmcnt(0)
    s_cmp_eq_u32 s32, 1
    s_cbranch_scc1 pw_1_ok
    s_sleep 1
    s_sub_u32 s12, s12, 1
    s_cbranch_scc0 pw_1
    s_mov_b32 s12, 0
pw_1_ok:
ld_uok:
    s_mul_i32 s3, s81, 4576
    s_add_u32 m0, s3, 115776
    s_nop 0
    buffer_load_dwordx4 v21, s[60:63], s77 offen offset:0 sc1 lds
    s_add_u32 s77, s77, 654336
    buffer_load_dwordx4 v21, s[60:63], s77 offen offset:1024 sc1 lds
    s_add_u32 s77, s77, 654336
    buffer_load_dwordx4 v21, s[60:63], s77 offen offset:2048 sc1 lds
    s_add_u32 s77, s77, 654336
    buffer_load_dwordx4 v21, s[60:63], s77 offen offset:3072 sc1 lds
pad_ll_4:
    s_cbranch_execz walk_done
    s_add_u32 m0, m0, 4096
    s_mov_b64 exec, 0x3fffffff
    buffer_load_dwordx4 v20, s[60:63], s62 offen lds
    s_lshl2_add_u32 m0, s81, 161888
    s_mov_b64 exec, 1
    buffer_load_dword v20, s[60:63], s62 offen offset:0 lds
    s_mov_b64 exec, -1
    s_branch g2pre
not_ld:
    s_lshr_b32 s3, s10, 1
    s_mul_i32 s3, s3, 27
    s_add_u32 s3, s3, s11
    s_lshr_b32 s8, s3, 2
    s_and_b32 s3, s3, 3
    s_and_b32 s4, s10, 1
    s_lshl2_add_u32 s7, s4, s3
    v_lshrrev_b32 v2, 8, v0
    v_lshlrev_b32 v0, 2, v0
    v_add_u32 v0, 161792, v0
    v_xor_b32 v2, 1, v2
    ds_write_b32 v0, v2
    s_and_b32 s3, s11, 3
    s_and_b32 s4, s10, 1
    s_lshl2_add_u32 s14, s4, s3
    s_lshr_b32 s3, s11, 2
    s_lshr_b32 s4, s10, 1
    s_lshl3_add_u32 s13, s4, s3
    s_mov_b32 s12, 65536
    s_mov_b32 s100, 0
    s_lshl_b32 s3, s14, 5
    s_add_u32 s3, s3, s13
    s_lshl_b32 s3, s3, 7
    s_add_u32 s51, s3, 0xa48000
    s_mov_b32 s75, 141312
    s_cmp_ge_u32 s11, 27
    s_cselect_b32 s15, 1, 0
    s_cselect_b32 s75, 116864, s75
    s_and_b32 s3, s7, 3
    s_lshl_b32 s3, s3, 2
    s_lshr_b32 s3, 0x3210, s3
    s_and_b32 s3, s3, 15
    s_and_b32 s4, s8, -2
    s_cmp_ge_u32 s8, 10
    s_addc_u32 s3, s3, s4
    s_mul_i32 s4, s3, 205
    s_lshr_b32 s4, s4, 11
    s_mul_i32 s4, s4, 10
    s_sub_u32 s9, s3, s4
    s_and_b32 s76, s6, 1
    s_and_b32 s5, s8, 1
    s_cmp_ge_u32 s8, 20
    s_cselect_b32 s5, 1, s5
    s_mov_b32 s71, s5
    s_lshl1_add_u32 s3, s7, s76
    s_lshl1_add_u32 s3, s3, s5
    s_lshl1_add_u32 s5, s5, s76
    s_lshl_b32 s69, s5, 13
    s_mul_i32 s4, s3, 81920
    s_sub_u32 s77, 0xe76000, s4
    s_lshl_b32 s4, s9, 12
    s_add_u32 s77, s77, s4
    s_mul_i32 s4, s3, 10
    s_add_u32 s4, s4, s9
    s_lshl_b32 s4, s4, 8
    s_add_u32 s78, s4, 0xa00000
    s_lshl3_add_u32 s4, s9, s7
    s_lshl_b32 s4, s4, 5
    s_and_b32 s3, s3, 3
    s_add_u32 s4, s4, s3
    s_lshl2_add_u32 s79, s4, 0xa50000
    v_lshrrev_b32 v5, 4, v1
    v_lshlrev_b32 v7, 4, v5
    v_lshlrev_b32 v15, 4, v1
    s_waitcnt lgkmcnt(0)
    s_mov_b32 s60, s48
    s_mov_b32 s61, s49
    s_mov_b32 s62, 0x1a00000
    s_mov_b32 s63, 0x20000
    s_mov_b32 s64, s42
    s_mov_b32 s65, s43
    s_mov_b32 s66, 0x500
    s_mov_b32 s67, 0x20000
    s_lshl_b32 s3, s9, 7
    buffer_load_dwordx4 v[24:27], v7, s[64:67], s3 offen offset:0
    buffer_load_dwordx4 v[28:31], v7, s[64:67], s3 offen offset:64
    s_mul_i32 s3, s10, 80
    s_lshl1_add_u32 s3, s11, s3
    s_add_u32 s3, s3, s76
    s_min_u32 s3, s3, 609
    s_lshl_b32 s3, s3, 1
    v_mov_b32 v23, s3
    global_load_ushort v23, v23, s[32:33] offset:60
    s_mov_b32 s56, s40
    s_mov_b32 s57, s41
    s_mov_b32 s58, 0x21c000
    s_mov_b32 s59, 0x20000
    v_bfe_u32 v4, v1, 3, 1
    v_bfe_u32 v6, v1, 4, 1
walk_4:
pad_hp0_0:
    s_cbranch_execz pad_hp0_1
    v_lshl_add_u32 v4, v6, 2, v4
    v_bfe_u32 v6, v1, 1, 1
    v_xor_b32 v4, v4, v6
    v_xor_b32 v4, 7, v4
    v_lshlrev_b32 v4, 4, v4
    v_and_b32 v6, 1, v1
    v_lshl_add_u32 v4, v6, 3, v4
    v_bfe_u32 v6, v1, 2, 2
    v_lshl_add_u32 v6, v5, 3, v6
    v_sub_u32 v6, 27, v6
    v_lshl_add_u32 v4, v6, 7, v4
    v_add_u32 v8, s69, v4
    v_xor_b32 v9, 32, v8
    v_xor_b32 v10, 64, v8
    v_xor_b32 v11, 96, v8
    v_and_b32 v4, 15, v1
    v_lshl_add_u32 v12, v4, 6, v7
    v_lshrrev_b32 v6, 1, v4
    v_xor_b32 v6, v5, v6
    v_lshlrev_b32 v6, 4, v6
    v_lshl_add_u32 v4, v4, 7, v6
    v_add_u32 v13, s69, v4
    v_xor_b32 v14, 64, v13
    s_mul_i32 s3, s10, 27
    s_add_u32 s3, s3, s11
    s_lshr_b32 s4, s3, 2
    s_and_b32 s3, s3, 3
    s_lshl1_add_u32 s3, s3, s76
    s_mul_i32 s80, s4, 40960
    s_mul_i32 s5, s3, 160
    s_add_u32 s80, s80, s5
    s_mul_i32 s5, s3, 54
    s_add_u32 s5, s5, s4
    s_mul_i32 s5, s5, 5120
    s_add_u32 s81, s5, 0x1000000
    s_lshl_b32 s68, s3, 7
    s_add_u32 s68, s68, s4
    s_cmp_ge_u32 s4, 14
    s_cselect_b32 s5, 18, 0
    s_add_u32 s68, s68, s5
    s_cmp_ge_u32 s4, 28
    s_cselect_b32 s5, 18, 0
    s_add_u32 s68, s68, s5
    s_cmp_ge_u32 s4, 41
    s_cselect_b32 s5, 19, 0
    s_add_u32 s68, s68, s5
    s_lshl2_add_u32 s68, s68, 0xa52800
    v_add_u32 v4, 0, v1
    v_mul_u32_u24 v6, 205, v4
pad_hp0_1:
    s_cbranch_execz pad_hp1_0
    v_lshrrev_b32 v6, 11, v6
    v_mul_u32_u24 v6, 1120, v6
    v_lshl_add_u32 v17, v4, 4, v6
    v_add_u32 v4, 64, v1
    v_mul_u32_u24 v6, 205, v4
    v_lshrrev_b32 v6, 11, v6
    v_mul_u32_u24 v6, 1120, v6
    v_lshl_add_u32 v18, v4, 4, v6
    v_subrev_u32 v18, 1024, v18
    v_add_u32 v4, 128, v1
    v_mul_u32_u24 v6, 205, v4
    v_lshrrev_b32 v6, 11, v6
    v_mul_u32_u24 v6, 1120, v6
    v_lshl_add_u32 v19, v4, 4, v6
    v_subrev_u32 v19, 2048, v19
    v_add_u32 v4, 192, v1
    v_mul_u32_u24 v6, 205, v4
    v_lshrrev_b32 v6, 11, v6
    v_mul_u32_u24 v6, 1120, v6
    v_lshl_add_u32 v20, v4, 4, v6
    v_subrev_u32 v20, 3072, v20
    v_add_u32 v4, 256, v1
    v_mul_u32_u24 v6, 205, v4
    v_lshrrev_b32 v6, 11, v6
    v_mul_u32_u24 v6, 1120, v6
    v_lshl_add_u32 v21, v4, 4, v6
    v_lshrrev_b32 v4, 2, v1
    v_mul_u32_u24 v4, 160, v4
    v_and_b32 v6, 3, v1
    v_lshl_add_u32 v4, v6, 3, v4
    s_lshl_b32 s3, s76, 13
    s_add_u32 s69, s3, 124928
    v_add_u32 v16, s69, v4
    s_mov_b32 s72, 0
    s_waitcnt vmcnt(0)
pad_hp1_0:
    s_cbranch_execz pad_hp1_1
    s_barrier
    s_cmp_eq_u32 s71, 0
    s_cbranch_scc1 hp_ut
pad_hp1_1:
    s_cbranch_execz walk_done
    s_barrier
    s_cmp_ge_u32 s8, 20
    s_cbranch_scc1 hp_nord
hp_ut:
    ds_read_b64_tr_b16 v[32:33], v8 offset:512
    ds_read_b64_tr_b16 v[34:35], v9 offset:0
    ds_read_b64_tr_b16 v[36:37], v9 offset:512
    ds_read_b64_tr_b16 v[38:39], v8 offset:0
    ds_read_b64_tr_b16 v[40:41], v10 offset:512
    ds_read_b64_tr_b16 v[42:43], v11 offset:0
    ds_read_b64_tr_b16 v[44:45], v11 offset:512
    ds_read_b64_tr_b16 v[46:47], v10 offset:0
    ds_read_b64_tr_b16 v[48:49], v8 offset:4608
    ds_read_b64_tr_b16 v[50:51], v9 offset:4096
    ds_read_b64_tr_b16 v[52:53], v9 offset:4608
    ds_read_b64_tr_b16 v[54:55], v8 offset:4096
    ds_read_b64_tr_b16 v[56:57], v10 offset:4608
    ds_read_b64_tr_b16 v[58:59], v11 offset:4096
    ds_read_b64_tr_b16 v[60:61], v11 offset:4608
    ds_read_b64_tr_b16 v[62:63], v10 offset:4096
    ds_read_b128 v[64:67], v13 offset:0
    ds_read_b128 v[68:71], v14 offset:0
    ds_read_b128 v[72:75], v13 offset:2048
    ds_read_b128 v[76:79], v14 offset:2048
    ds_read_b128 v[80:83], v13 offset:4096
    ds_read_b128 v[84:87], v14 offset:4096
    ds_read_b128 v[88:91], v13 offset:6144
    ds_read_b128 v[92:95], v14 offset:6144
    s_sub_u32 s3, s77, 40960
    s_waitcnt lgkmcnt(0)
hp_nord:
    s_barrier
    s_cmp_ge_u32 s8, 20
    s_cbranch_scc1 hp_nout
    buffer_store_dwordx4 v[32:35], v12, s[60:63], s77 offen offset:0 sc1
    v_mfma_f32_16x16x32_bf16 v[96:99], v[24:27], v[64:67], 0
    buffer_store_dwordx4 v[36:39], v12, s[60:63], s77 offen offset:1024 sc1
walk_5:
pad_hp1_2:
    s_cbranch_execz pad_hp1_3
    v_mfma_f32_16x16x32_bf16 v[100:103], v[24:27], v[72:75], 0
    buffer_store_dwordx4 v[40:43], v12, s[60:63], s77 offen offset:2048 sc1
    v_mfma_f32_16x16x32_bf16 v[104:107], v[24:27], v[80:83], 0
    buffer_store_dwordx4 v[44:47], v12, s[60:63], s77 offen offset:3072 sc1
    v_mfma_f32_16x16x32_bf16 v[108:111], v[24:27], v[88:91], 0
    buffer_store_dwordx4 v[48:51], v12, s[60:63], s3 offen offset:0 sc1
    v_mfma_f32_16x16x32_bf16 v[96:99], v[28:31], v[68:71], v[96:99]
    buffer_store_dwordx4 v[52:55], v12, s[60:63], s3 offen offset:1024 sc1
    v_mfma_f32_16x16x32_bf16 v[100:103], v[28:31], v[76:79], v[100:103]
    buffer_store_dwordx4 v[56:59], v12, s[60:63], s3 offen offset:2048 sc1
    v_mfma_f32_16x16x32_bf16 v[104:107], v[28:31], v[84:87], v[104:107]
    buffer_store_dwordx4 v[60:63], v12, s[60:63], s3 offen offset:3072 sc1
    v_mfma_f32_16x16x32_bf16 v[108:111], v[28:31], v[92:95], v[108:111]
    s_cmp_lg_u32 s71, 0
    s_cbranch_scc1 hp_nout
    s_barrier
hp_nout:
    v_and_b32 v22, 7, v1
    v_lshlrev_b32 v22, 2, v22
    global_load_dword v22, v22, s[46:47] sc1
    s_cmp_ge_u32 s8, 20
    s_cbranch_scc1 hp_nog
    v_lshlrev_b32 v4, 2, v1
    v_cmp_le_u32 vcc, 16, v1
    s_nop 1
    v_cndmask_b32 v96, v96, v100, vcc
    v_cmp_le_u32 vcc, 32, v1
    s_nop 1
    v_cndmask_b32 v96, v96, v104, vcc
    v_cmp_le_u32 vcc, 48, v1
    s_nop 1
    v_cndmask_b32 v96, v96, v108, vcc
    buffer_store_dword v96, v4, s[60:63], s78 offen sc1
hp_nog:
    s_barrier
    s_getreg_b32 s3, hwreg(HW_REG_IB_STS, 0, 4)
    s_or_b32 s3, s3, s72
    s_cbranch_scc1 hp_u_2
    s_waitcnt vmcnt(0)
    v_cmp_ne_u32 vcc, 1, v22
    s_nop 0
    s_cbranch_vccz zc_3
spin_4:
    v_and_b32 v22, 7, v1
    v_lshlrev_b32 v22, 2, v22
    global_load_dword v22, v22, s[46:47] sc1
    s_waitcnt vmcnt(0)
    v_cmp_ne_u32 vcc, 1, v22
    s_nop 0
    s_cbranch_vccz spin_4_ok
pad_hp1_3:
    s_cbranch_execz pad_hp1_4
    s_sleep 2
    s_sub_u32 s12, s12, 1
    s_cbranch_scc0 spin_4
    s_mov_b32 s12, 0
spin_4_ok:
zc_3:
    s_mov_b32 s72, 1
    s_cmp_ge_u32 s8, 20
    s_cbranch_scc1 hp_u_2
    v_mov_b32 v4, 0
    v_mov_b32 v5, 1
    s_mov_b64 exec, 1
    buffer_store_dword v5, v4, s[60:63], s79 offen sc1
    s_mov_b64 exec, -1
hp_u_2:
    s_cmp_ge_u32 s11, 25
    s_cbranch_scc1 hp_k_5
    s_mul_i32 s3, s76, 17408
    s_add_u32 s3, s3, 115776
    v_add_u32 v65, s3, v15
    ds_read_b128 v[96:99], v65 offset:0
    ds_read_b128 v[100:103], v65 offset:1024
    ds_read_b128 v[104:107], v65 offset:2048
    ds_read_b128 v[108:111], v65 offset:3072
    s_add_u32 s3, s3, 8704
    v_add_u32 v64, s3, v15
    ds_read_b128 v[32:35], v64 offset:0
    ds_read_b128 v[36:39], v64 offset:1024
    ds_read_b128 v[40:43], v64 offset:2048
    ds_read_b128 v[44:47], v64 offset:3072
    s_waitcnt lgkmcnt(3)
    v_add_f32 v96, v96, v32
    v_add_f32 v97, v97, v33
    v_add_f32 v98, v98, v34
    v_add_f32 v99, v99, v35
    s_waitcnt lgkmcnt(2)
    v_add_f32 v100, v100, v36
    v_add_f32 v101, v101, v37
    v_add_f32 v102, v102, v38
    v_add_f32 v103, v103, v39
    s_waitcnt lgkmcnt(1)
    v_add_f32 v104, v104, v40
    v_add_f32 v105, v105, v41
    v_add_f32 v106, v106, v42
    v_add_f32 v107, v107, v43
    s_waitcnt lgkmcnt(0)
    v_add_f32 v108, v108, v44
    v_add_f32 v109, v109, v45
    v_add_f32 v110, v110, v46
    v_add_f32 v111, v111, v47
    s_mul_i32 s3, s76, 8736
    s_add_u32 s70, s3, 98304
hp_k_5:
pad_hp1_4:
    s_cbranch_execz pad_hp1_5
    s_barrier
    s_getreg_b32 s3, hwreg(HW_REG_IB_STS, 0, 4)
    s_or_b32 s3, s3, s72
    s_cbranch_scc1 hp_u_6
    s_waitcnt vmcnt(0)
    v_cmp_ne_u32 vcc, 1, v22
    s_nop 0
    s_cbranch_vccz zc_7
spin_8:
    v_and_b32 v22, 7, v1
    v_lshlrev_b32 v22, 2, v22
    global_load_dword v22, v22, s[46:47] sc1
    s_waitcnt vmcnt(0)
    v_cmp_ne_u32 vcc, 1, v22
    s_nop 0
    s_cbranch_vccz spin_8_ok
    s_sleep 2
    s_sub_u32 s12, s12, 1
    s_cbranch_scc0 spin_8
    s_mov_b32 s12, 0
spin_8_ok:
zc_7:
    s_mov_b32 s72, 1
    s_cmp_ge_u32 s8, 20
    s_cbranch_scc1 hp_u_6
    v_mov_b32 v4, 0
    v_mov_b32 v5, 1
    s_mov_b64 exec, 1
    buffer_store_dword v5, v4, s[60:63], s79 offen sc1
    s_mov_b64 exec, -1
hp_u_6:
    s_cmp_ge_u32 s11, 25
    s_cbranch_scc1 hp_k_9
    v_lshlrev_b32 v23, 16, v23
    v_cmp_eq_u32 vcc, 0, v1
    s_nop 1
    v_cndmask_b32 v68, 0, v23, vcc
    v_and_b32 v69, 1, v1
    v_cmp_eq_u32 vcc, 0, v69
    v_mov_b32 v71, 0
    v_add_f32 v96, v96, v68
    v_mov_b32_dpp v103, v104 wave_rol:1 row_mask:0xf bank_mask:0xf
    s_nop 1
    v_mov_b32_dpp v103, v102 wave_shl:1 row_mask:0xf bank_mask:0xf
    v_mov_b32_dpp v106, v108 wave_rol:1 row_mask:0xf bank_mask:0xf
    s_nop 1
    v_mov_b32_dpp v106, v104 wave_shl:1 row_mask:0xf bank_mask:0xf
    v_mov_b32_dpp v107, v109 wave_rol:1 row_mask:0xf bank_mask:0xf
    s_nop 1
    v_mov_b32_dpp v107, v108 wave_shl:1 row_mask:0xf bank_mask:0xf
    v_mov_b32_dpp v111, v110 wave_rol:1 row_mask:0xf bank_mask:0xf
    s_nop 1
    v_mov_b32_dpp v111, v109 wave_shl:1 row_mask:0xf bank_mask:0xf
    v_mov_b32_dpp v102, v103 quad_perm:[0,1,2,3] row_mask:0xc bank_mask:0xf
    v_cvt_pk_bf16_f32 v32, v96, v97
pad_hp1_5:
    s_cbranch_execz pad_hp1_6
    v_cvt_pk_bf16_f32 v33, v98, v99
    v_cvt_pk_bf16_f32 v34, v100, v100
    v_cvt_pk_bf16_f32 v36, v104, v104
    v_cvt_pk_bf16_f32 v37, v104, v105
    v_cvt_pk_bf16_f32 v38, v105, v105
    v_cvt_pk_bf16_f32 v39, v106, v106
    v_cvt_pk_bf16_f32 v35, v101, v102
    v_cndmask_b32 v70, v107, v108, vcc
    v_cvt_pk_bf16_f32 v40, v108, v108
    v_cvt_pk_bf16_f32 v43, v107, v107
    v_cvt_pk_bf16_f32 v42, v70, v107
    v_mov_b32 v41, v40
    v_cndmask_b32 v70, v111, v109, vcc
    v_cvt_pk_bf16_f32 v44, v109, v109
    v_cvt_pk_bf16_f32 v47, v111, v111
    v_cvt_pk_bf16_f32 v46, v70, v111
    v_mov_b32 v45, v44
    v_permlane32_swap_b32 v32, v34
    v_permlane32_swap_b32 v33, v35
hp_k_9:
    s_barrier
    s_getreg_b32 s3, hwreg(HW_REG_IB_STS, 0, 4)
    s_or_b32 s3, s3, s72
    s_cbranch_scc1 hp_u_10
    s_waitcnt vmcnt(0)
    v_cmp_ne_u32 vcc, 1, v22
    s_nop 0
    s_cbranch_vccz zc_11
spin_12:
    v_and_b32 v22, 7, v1
    v_lshlrev_b32 v22, 2, v22
    global_load_dword v22, v22, s[46:47] sc1
    s_waitcnt vmcnt(0)
    v_cmp_ne_u32 vcc, 1, v22
    s_nop 0
    s_cbranch_vccz spin_12_ok
    s_sleep 2
    s_sub_u32 s12, s12, 1
    s_cbranch_scc0 spin_12
    s_mov_b32 s12, 0
spin_12_ok:
zc_11:
    s_mov_b32 s72, 1
    s_cmp_ge_u32 s8, 20
    s_cbranch_scc1 hp_u_10
    v_mov_b32 v4, 0
    v_mov_b32 v5, 1
    s_mov_b64 exec, 1
    buffer_store_dword v5, v4, s[60:63], s79 offen sc1
    s_mov_b64 exec, -1
hp_u_10:
    s_cmp_ge_u32 s11, 25
    s_cbranch_scc1 hp_k_13
pad_hp1_6:
    s_cbranch_execz walk_done
    v_mov_b32_dpp v71, v35 wave_shr:1 row_mask:0xf bank_mask:0xf
    v_alignbit_b32 v51, v35, v34, 16
    v_alignbit_b32 v50, v34, v33, 16
    v_alignbit_b32 v49, v33, v32, 16
    v_alignbit_b32 v48, v32, v71, 16
    v_mov_b32_dpp v71, v35 wave_ror:1 row_mask:0xf bank_mask:0xf
    s_nop 1
    v_mov_b32_dpp v71, v39 wave_shr:1 row_mask:0xf bank_mask:0xf
    v_alignbit_b32 v55, v39, v38, 16
    v_alignbit_b32 v54, v38, v37, 16
    v_alignbit_b32 v53, v37, v36, 16
    v_alignbit_b32 v52, v36, v71, 16
    v_mov_b32_dpp v71, v39 wave_ror:1 row_mask:0xf bank_mask:0xf
    s_nop 1
    v_mov_b32_dpp v71, v43 wave_shr:1 row_mask:0xf bank_mask:0xf
    v_alignbit_b32 v59, v43, v42, 16
    v_alignbit_b32 v58, v42, v41, 16
    v_alignbit_b32 v57, v41, v40, 16
    v_alignbit_b32 v56, v40, v71, 16
    v_mov_b32_dpp v71, v43 wave_ror:1 row_mask:0xf bank_mask:0xf
    s_nop 1
    v_mov_b32_dpp v71, v47 wave_shr:1 row_mask:0xf bank_mask:0xf
    v_alignbit_b32 v63, v47, v46, 16
    v_alignbit_b32 v62, v46, v45, 16
    v_alignbit_b32 v61, v45, v44, 16
    v_alignbit_b32 v60, v44, v71, 16
hp_k_13:
    s_mov_b32 m0, s69
    s_nop 0
    buffer_load_dwordx4 v17, s[56:59], s80 offen offset:0 lds
    buffer_load_dwordx4 v18, s[56:59], s80 offen offset:1024 lds
    buffer_load_dwordx4 v19, s[56:59], s80 offen offset:2048 lds
    buffer_load_dwordx4 v20, s[56:59], s80 offen offset:3072 lds
    s_add_u32 m0, m0, 4096
    s_nop 0
    buffer_load_dwordx4 v21, s[56:59], s80 offen lds
walk_6:
pad_hp1_7:
    s_cbranch_execz pad_hp1_8
    v_and_b32 v164, 3, v1
    v_lshl_add_u32 v164, v164, 3, v16
    s_barrier
    s_cmp_lg_u32 s72, 0
    s_cbranch_scc1 hp_u_14
    s_waitcnt vmcnt(0)
    v_cmp_ne_u32 vcc, 1, v22
    s_nop 0
    s_cbranch_vccz zc_15
spin_16:
    v_and_b32 v22, 7, v1
    v_lshlrev_b32 v22, 2, v22
    global_load_dword v22, v22, s[46:47] sc1
    s_waitcnt vmcnt(0)
    v_cmp_ne_u32 vcc, 1, v22
    s_nop 0
    s_cbranch_vccz spin_16_ok
    s_sleep 2
    s_sub_u32 s12, s12, 1
    s_cbranch_scc0 spin_16
    s_mov_b32 s12, 0
spin_16_ok:
zc_15:
    s_mov_b32 s72, 1
    s_cmp_ge_u32 s8, 20
    s_cbranch_scc1 hp_u_14
    v_mov_b32 v4, 0
    v_mov_b32 v5, 1
    s_mov_b64 exec, 1
    buffer_store_dword v5, v4, s[60:63], s79 offen sc1
    s_mov_b64 exec, -1
hp_u_14:
    s_cmp_ge_u32 s11, 25
    s_cbranch_scc1 hp_k_17
    v_mov_b64 v[112:113], 0
    v_mov_b64 v[114:115], 0
    v_lshrrev_b32 v64, 1, v1
    v_mul_u32_u24 v64, 4160, v64
    v_lshl_add_u32 v64, v69, 4, v64
    v_add_u32 v65, s70, v15
    v_add_u32 v64, s70, v64
    ds_write_b128 v65, v[32:35] offset:32
    ds_write_b128 v65, v[48:51] offset:4192
    ds_write_b128 v65, v[36:39] offset:1056
    ds_write_b128 v65, v[52:55] offset:5216
    ds_write_b128 v65, v[40:43] offset:2080
    ds_write_b128 v65, v[56:59] offset:6240
    ds_write_b128 v65, v[44:47] offset:3104
    ds_write_b128 v65, v[60:63] offset:7264
    s_mov_b64 exec, 15
    ds_write_b128 v64, v[112:115]
    s_mov_b64 exec, -1
hp_k_17:
pad_hp1_8:
    s_cbranch_execz pad_sd_0
    s_barrier
    s_barrier
    s_waitcnt vmcnt(0)
    ds_read_b64_tr_b16 v[144:145], v164 offset:0
    ds_read_b64_tr_b16 v[146:147], v164 offset:2560
    ds_read_b64_tr_b16 v[148:149], v164 offset:8
    ds_read_b64_tr_b16 v[150:151], v164 offset:2568
    ds_read_b64_tr_b16 v[152:153], v164 offset:64
    ds_read_b64_tr_b16 v[154:155], v164 offset:2624
    ds_read_b64_tr_b16 v[156:157], v164 offset:72
    ds_read_b64_tr_b16 v[158:159], v164 offset:2632
    ds_read_b64_tr_b16 v[160:161], v16 offset:128
    ds_read_b64_tr_b16 v[162:163], v16 offset:2688
    s_barrier
    s_add_u32 s3, s81, 4096
    s_waitcnt lgkmcnt(0)
    buffer_store_dwordx4 v[144:147], v15, s[60:63], s81 offen offset:0 sc1
    buffer_store_dwordx4 v[148:151], v15, s[60:63], s81 offen offset:1024 sc1
    buffer_store_dwordx4 v[152:155], v15, s[60:63], s81 offen offset:2048 sc1
    buffer_store_dwordx4 v[156:159], v15, s[60:63], s81 offen offset:3072 sc1
    buffer_store_dwordx4 v[160:163], v15, s[60:63], s3 offen offset:0 sc1
    s_barrier
    s_barrier
    s_waitcnt vmcnt(0)
    v_mov_b32 v4, 0
    v_mov_b32 v5, 1
    s_mov_b64 exec, 1
    buffer_store_dword v5, v4, s[60:63], s68 offen sc1
    s_mov_b64 exec, -1
    s_barrier
    s_barrier
    s_barrier
    s_barrier
    s_barrier
    s_and_b32 s3, s6, 3
    s_lshl2_add_u32 s3, s14, s3
    s_lshl_b32 s3, s3, 7
    s_add_u32 s3, s3, 0xa52800
    s_buffer_load_dwordx16 s[16:31], s[60:63], s3 glc
    s_barrier
    s_branch g2pre
walk_far:
    s_cmp_eq_u32 s3, 4
    s_cbranch_scc1 walk_4
    s_cmp_eq_u32 s3, 5
    s_cbranch_scc1 walk_5
    s_cmp_eq_u32 s3, 6
    s_cbranch_scc1 walk_6
    s_branch walk_7
walk_done:
    s_mov_b64 exec, -1
    s_lshr_b32 s50, s6, 1
    s_mov_b32 s68, 0
    s_branch kg_no
kg_in:
    global_load_ushort v247, v97, s[32:33]
kg_no:
    s_lshr_b32 s3, s10, 1
    s_mul_i32 s3, s3, 27
    s_add_u32 s3, s3, s11
    s_lshr_b32 s8, s3, 2
    s_and_b32 s3, s3, 3
    s_and_b32 s4, s10, 1
    s_lshl2_add_u32 s7, s4, s3
    v_lshrrev_b32 v2, 8, v0
    v_lshlrev_b32 v0, 2, v0
    v_add_u32 v0, 161792, v0
    v_xor_b32 v2, 1, v2
    ds_write_b32 v0, v2
    s_and_b32 s3, s11, 3
    s_and_b32 s4, s10, 1
    s_lshl2_add_u32 s14, s4, s3
    s_lshr_b32 s3, s11, 2
    s_lshr_b32 s4, s10, 1
    s_lshl3_add_u32 s13, s4, s3
    s_mov_b32 s12, 65536
    s_mov_b32 s100, 0
    s_lshl_b32 s3, s14, 5
    s_add_u32 s3, s3, s13
    s_lshl_b32 s3, s3, 7
    s_add_u32 s51, s3, 0xa48000
    s_mov_b32 s75, 141312
    s_cmp_ge_u32 s11, 27
    s_cselect_b32 s15, 1, 0
    s_cselect_b32 s75, 116864, s75
    s_cmp_lg_u32 s15, 0
    s_cbranch_scc1 ch_side
    s_mov_b32 s3, s50
    s_mul_i32 s4, s3, 8736
    s_add_u32 s69, s4, 98304
    s_mul_i32 s4, s3, 4576
    s_add_u32 s70, s4, 115776
    s_lshl_b32 s4, s3, 13
    s_add_u32 s74, s4, 124928
    s_and_b32 s3, s6, 1
    s_add_u32 s73, s3, 1
    s_branch ch_join
ch_side:
    s_mul_i32 s4, s50, 8736
    s_add_u32 s69, s4, 81920
walk_0:
pad_st_0:
    s_cbranch_execz pad_st_1
    s_mul_i32 s4, s50, 4576
    s_add_u32 s70, s4, 134336
    s_and_b32 s3, s6, 1
    s_mul_i32 s3, s3, 20480
    s_add_u32 s74, s3, 51200
    s_lshr_b32 s3, s6, 1
    s_lshl_b32 s3, s3, 2
    s_lshr_b32 s3, 0x1200, s3
    s_and_b32 s73, s3, 3
ch_join:
    s_cmp_eq_u32 s73, 2
    s_cselect_b32 s71, 256, 0
    s_cmp_eq_u32 s73, 0
    s_cselect_b32 s72, 4, 2
    s_lshl_b32 s50, s50, 2
    s_mul_i32 s3, s6, 8704
    s_mul_i32 s4, s15, 115776
    s_add_u32 s3, s3, 115776
    s_sub_u32 m0, s3, s4
    s_cmp_eq_u32 s73, 2
    s_cselect_b32 s3, 0x2020000, 0
    s_add_u32 s77, s3, 0x1000c0c
    s_lshr_b32 s76, s72, 1
    s_waitcnt lgkmcnt(0)
    s_mov_b32 s60, s48
    s_mov_b32 s61, s49
    s_mov_b32 s62, 0x1a00000
    s_mov_b32 s63, 0x20000
    s_mov_b32 s64, s44
    s_mov_b32 s65, s45
    s_mov_b32 s66, 0x280000
    s_mov_b32 s67, 0x20000
    v_and_b32 v100, 31, v1
    v_lshrrev_b32 v101, 5, v1
    v_mul_u32_u24 v252, 272, v100
    v_lshl_add_u32 v252, v101, 4, v252
    v_add_u32 v252, m0, v252
    v_lshlrev_b32 v253, 4, v1
    v_mov_b64 v[16:17], 0
    v_mov_b64 v[18:19], 0
    v_mov_b64 v[20:21], 0
    v_mov_b64 v[22:23], 0
    v_mov_b64 v[24:25], 0
    v_mov_b64 v[26:27], 0
    v_mov_b64 v[28:29], 0
    v_mov_b64 v[30:31], 0
pad_st_1:
    s_cbranch_execz pad_st_2
    s_cmp_eq_u32 s15, 0
    s_cbranch_scc1 g_addr
    s_barrier
    s_lshl3_add_u32 s3, s11, s6
    s_cmp_lg_u32 s3, 254
    s_cbranch_scc1 kg_go
    v_mov_b64 v[32:33], 0
    v_mov_b64 v[34:35], 0
    s_mul_i32 s3, s10, 10240
    s_add_u32 s3, s3, 0xa40000
    buffer_store_dwordx4 v[32:35], v253, s[60:63], s3 offen offset:0 sc1
    buffer_store_dwordx4 v[32:35], v253, s[60:63], s3 offen offset:1024 sc1
    buffer_store_dwordx4 v[32:35], v253, s[60:63], s3 offen offset:2048 sc1
    buffer_store_dwordx4 v[32:35], v253, s[60:63], s3 offen offset:3072 sc1
    s_add_u32 s3, s3, 4096
    buffer_store_dwordx4 v[32:35], v253, s[60:63], s3 offen offset:0 sc1
    buffer_store_dwordx4 v[32:35], v253, s[60:63], s3 offen offset:1024 sc1
    buffer_store_dwordx4 v[32:35], v253, s[60:63], s3 offen offset:2048 sc1
    buffer_store_dwordx4 v[32:35], v253, s[60:63], s3 offen offset:3072 sc1
    s_add_u32 s3, s3, 4096
    buffer_store_dwordx4 v[32:35], v253, s[60:63], s3 offen offset:0 sc1
    buffer_store_dwordx4 v[32:35], v253, s[60:63], s3 offen offset:1024 sc1
    s_waitcnt vmcnt(0)
    s_lshl_b32 s3, s10, 2
    v_mov_b32 v32, s3
    v_mov_b32 v33, 1
    s_mov_b64 exec, 1
    global_store_dword v32, v33, s[46:47] sc1
    s_mov_b64 exec, -1
    s_branch kg_go
g_addr:
    v_and_b32 v11, 15, v1
    v_lshrrev_b32 v12, 4, v1
    v_lshrrev_b32 v13, 1, v11
    v_xor_b32 v13, v12, v13
    v_lshlrev_b32 v13, 4, v13
    v_lshl_add_u32 v11, v11, 7, v13
    s_and_b32 s3, s6, 1
    s_lshl_b32 s3, s3, 13
    v_add_u32 v4, s3, v11
    v_xor_b32 v5, 64, v4
    v_bfe_u32 v13, v1, 2, 2
    v_lshl_add_u32 v11, v12, 3, v13
    v_lshlrev_b32 v11, 7, v11
    v_bfe_u32 v13, v1, 3, 2
pad_st_2:
    s_cbranch_execz pad_st_3
    s_and_b32 s3, s6, 2
    v_xor_b32 v13, s3, v13
    v_lshl_add_u32 v11, v13, 5, v11
    v_and_b32 v13, 3, v1
    v_lshl_add_u32 v11, v13, 3, v11
    v_add_u32 v6, 65536, v11
    v_xor_b32 v7, 32, v6
    v_lshlrev_b32 v8, 4, v1
    s_and_b32 s3, s6, 1
    s_lshl2_add_u32 s3, s3, 161792
    v_mov_b32 v9, s3
    v_mov_b64 v[112:113], 0
    v_mov_b64 v[114:115], 0
    v_mov_b64 v[116:117], 0
    v_mov_b64 v[118:119], 0
    v_mov_b64 v[120:121], 0
    v_mov_b64 v[122:123], 0
    v_mov_b64 v[124:125], 0
    v_mov_b64 v[126:127], 0
    v_mov_b64 v[128:129], 0
    v_mov_b64 v[130:131], 0
    v_mov_b64 v[132:133], 0
    v_mov_b64 v[134:135], 0
    v_mov_b64 v[136:137], 0
    v_mov_b64 v[138:139], 0
    v_mov_b64 v[140:141], 0
    v_mov_b64 v[142:143], 0
    v_mov_b64 v[144:145], 0
    v_mov_b64 v[146:147], 0
    v_mov_b64 v[148:149], 0
    v_mov_b64 v[150:151], 0
    v_mov_b64 v[152:153], 0
    v_mov_b64 v[154:155], 0
    v_mov_b64 v[156:157], 0
    v_mov_b64 v[158:159], 0
    v_mov_b64 v[160:161], 0
    v_mov_b64 v[162:163], 0
    v_mov_b64 v[164:165], 0
    v_mov_b64 v[166:167], 0
    v_mov_b64 v[168:169], 0
    v_mov_b64 v[170:171], 0
    v_mov_b64 v[172:173], 0
    v_mov_b64 v[174:175], 0
    v_mov_b64 v[176:177], 0
    v_mov_b64 v[178:179], 0
    v_mov_b64 v[180:181], 0
    v_mov_b64 v[182:183], 0
    v_mov_b64 v[184:185], 0
    v_mov_b64 v[186:187], 0
    v_mov_b64 v[188:189], 0
    v_mov_b64 v[190:191], 0
    v_mov_b64 v[192:193], 0
    v_mov_b64 v[194:195], 0
    v_mov_b64 v[196:197], 0
    v_mov_b64 v[198:199], 0
    v_mov_b64 v[200:201], 0
    v_mov_b64 v[202:203], 0
    v_mov_b64 v[204:205], 0
pad_st_3:
    s_cbranch_execz pad_kg_6
    v_mov_b64 v[206:207], 0
    v_mov_b64 v[208:209], 0
    v_mov_b64 v[210:211], 0
    v_mov_b64 v[212:213], 0
    v_mov_b64 v[214:215], 0
    v_mov_b64 v[216:217], 0
    v_mov_b64 v[218:219], 0
    v_mov_b64 v[220:221], 0
    v_mov_b64 v[222:223], 0
    v_mov_b64 v[224:225], 0
    v_mov_b64 v[226:227], 0
    v_mov_b64 v[228:229], 0
    v_mov_b64 v[230:231], 0
    v_mov_b64 v[232:233], 0
    v_mov_b64 v[234:235], 0
    v_mov_b64 v[236:237], 0
    v_mov_b64 v[238:239], 0
    s_cmp_ge_u32 s11, 25
    s_cbranch_scc1 gemm
kg_go:
    s_waitcnt vmcnt(1)
kg_go2:
walk_1:
pad_kg_0:
    s_cbranch_execz pad_kg_1
    v_lshlrev_b32 v246, 16, v246
    v_mul_f32 v246, 0x3fb8aa3b, v246
    v_exp_f32 v246, v246
    v_mov_b32 v100, 0x3f80
    v_cvt_pk_bf16_f32 v246, v246, v246
    v_and_b32 v246, 0xffff0000, v246
    v_perm_b32 v96, v240, v240, s77
    v_perm_b32 v97, v241, v241, s77
    v_mul_f32 v96, v246, v96
    v_mul_f32 v97, v246, v97
    v_mul_f32 v96, 0x3fb8aa3b, v96
    v_mul_f32 v97, 0x3e22f983, v97
    v_mul_f32 v98, 0x41000000, v96
    v_mul_f32 v99, 0x41000000, v97
    v_fract_f32 v99, v99
    v_exp_f32 v98, v98
    v_cos_f32 v106, v99
    v_sin_f32 v107, v99
    v_fract_f32 v97, v97
    v_exp_f32 v96, v96
    v_cos_f32 v104, v97
    v_sin_f32 v105, v97
    v_pk_mul_f32 v[106:107], v[106:107], v[98:99] op_sel_hi:[1,0]
    v_pk_mul_f32 v[104:105], v[104:105], v[96:97] op_sel_hi:[1,0]
kg_loop:
    ds_write_addtid_b32 v100
    v_pk_mul_f32 v[108:109], v[106:107], v[106:107] op_sel:[0,0] op_sel_hi:[0,1]
    v_pk_fma_f32 v[108:109], v[106:107], v[106:107], v[108:109] op_sel:[1,1,0] op_sel_hi:[1,0,1] neg_lo:[0,1,0]
    v_cvt_pk_bf16_f32 v248, v108, v109
pad_kg_1:
    s_cbranch_execz pad_kg_2
    v_cvt_pk_bf16_f32 v249, v106, v107
    ds_write_addtid_b32 v248 offset:544
    ds_write_addtid_b32 v249 offset:272
    v_pk_mul_f32 v[70:71], v[106:107], v[108:109] op_sel:[0,0] op_sel_hi:[0,1]
    v_pk_mul_f32 v[64:65], v[108:109], v[108:109] op_sel:[0,0] op_sel_hi:[0,1]
    v_pk_fma_f32 v[70:71], v[106:107], v[108:109], v[70:71] op_sel:[1,1,0] op_sel_hi:[1,0,1] neg_lo:[0,1,0]
    v_pk_fma_f32 v[64:65], v[108:109], v[108:109], v[64:65] op_sel:[1,1,0] op_sel_hi:[1,0,1] neg_lo:[0,1,0]
    v_cvt_pk_bf16_f32 v250, v70, v71
    v_cvt_pk_bf16_f32 v251, v64, v65
    ds_write_addtid_b32 v250 offset:816
    ds_write_addtid_b32 v251 offset:1088
    v_pk_mul_f32 v[66:67], v[70:71], v[108:109] op_sel:[0,0] op_sel_hi:[0,1]
    v_pk_mul_f32 v[68:69], v[64:65], v[108:109] op_sel:[0,0] op_sel_hi:[0,1]
    v_pk_fma_f32 v[66:67], v[70:71], v[108:109], v[66:67] op_sel:[1,1,0] op_sel_hi:[1,0,1] neg_lo:[0,1,0]
    v_pk_fma_f32 v[68:69], v[64:65], v[108:109], v[68:69] op_sel:[1,1,0] op_sel_hi:[1,0,1] neg_lo:[0,1,0]
    v_cvt_pk_bf16_f32 v248, v66, v67
    v_cvt_pk_bf16_f32 v249, v68, v69
    ds_write_addtid_b32 v248 offset:1360
    ds_write_addtid_b32 v249 offset:1632
    v_pk_mul_f32 v[70:71], v[66:67], v[108:109] op_sel:[0,0] op_sel_hi:[0,1]
    v_pk_mul_f32 v[64:65], v[68:69], v[108:109] op_sel:[0,0] op_sel_hi:[0,1]
    v_pk_fma_f32 v[70:71], v[66:67], v[108:109], v[70:71] op_sel:[1,1,0] op_sel_hi:[1,0,1] neg_lo:[0,1,0]
    v_pk_fma_f32 v[64:65], v[68:69], v[108:109], v[64:65] op_sel:[1,1,0] op_sel_hi:[1,0,1] neg_lo:[0,1,0]
    v_cvt_pk_bf16_f32 v250, v70, v71
    v_cvt_pk_bf16_f32 v251, v64, v65
    ds_write_addtid_b32 v250 offset:1904
    ds_write_addtid_b32 v251 offset:2176
    v_pk_mul_f32 v[66:67], v[70:71], v[108:109] op_sel:[0,0] op_sel_hi:[0,1]
    v_pk_mul_f32 v[68:69], v[64:65], v[108:109] op_sel:[0,0] op_sel_hi:[0,1]
    v_pk_fma_f32 v[66:67], v[70:71], v[108:109], v[66:67] op_sel:[1,1,0] op_sel_hi:[1,0,1] neg_lo:[0,1,0]
    v_pk_fma_f32 v[68:69], v[64:65], v[108:109], v[68:69] op_sel:[1,1,0] op_sel_hi:[1,0,1] neg_lo:[0,1,0]
pad_kg_2:
    s_cbranch_execz pad_kg_8
    v_cvt_pk_bf16_f32 v248, v66, v67
    v_cvt_pk_bf16_f32 v249, v68, v69
    ds_write_addtid_b32 v248 offset:2448
    ds_write_addtid_b32 v249 offset:2720
    v_pk_mul_f32 v[70:71], v[66:67], v[108:109] op_sel:[0,0] op_sel_hi:[0,1]
    v_pk_mul_f32 v[64:65], v[68:69], v[108:109] op_sel:[0,0] op_sel_hi:[0,1]
    v_pk_fma_f32 v[70:71], v[66:67], v[108:109], v[70:71] op_sel:[1,1,0] op_sel_hi:[1,0,1] neg_lo:[0,1,0]
    v_pk_fma_f32 v[64:65], v[68:69], v[108:109], v[64:65] op_sel:[1,1,0] op_sel_hi:[1,0,1] neg_lo:[0,1,0]
    v_cvt_pk_bf16_f32 v250, v70, v71
    v_cvt_pk_bf16_f32 v251, v64, v65
    ds_write_addtid_b32 v250 offset:2992
    ds_write_addtid_b32 v251 offset:3264
    v_pk_mul_f32 v[66:67], v[70:71], v[108:109] op_sel:[0,0] op_sel_hi:[0,1]
    v_pk_mul_f32 v[68:69], v[64:65], v[108:109] op_sel:[0,0] op_sel_hi:[0,1]
    v_pk_fma_f32 v[66:67], v[70:71], v[108:109], v[66:67] op_sel:[1,1,0] op_sel_hi:[1,0,1] neg_lo:[0,1,0]
    v_pk_fma_f32 v[68:69], v[64:65], v[108:109], v[68:69] op_sel:[1,1,0] op_sel_hi:[1,0,1] neg_lo:[0,1,0]
    v_cvt_pk_bf16_f32 v248, v66, v67
    v_cvt_pk_bf16_f32 v249, v68, v69
    ds_write_addtid_b32 v248 offset:3536
    ds_write_addtid_b32 v249 offset:3808
    v_pk_mul_f32 v[70:71], v[66:67], v[108:109] op_sel:[0,0] op_sel_hi:[0,1]
    v_pk_mul_f32 v[64:65], v[68:69], v[108:109] op_sel:[0,0] op_sel_hi:[0,1]
    v_pk_fma_f32 v[70:71], v[66:67], v[108:109], v[70:71] op_sel:[1,1,0] op_sel_hi:[1,0,1] neg_lo:[0,1,0]
    v_pk_fma_f32 v[64:65], v[68:69], v[108:109], v[64:65] op_sel:[1,1,0] op_sel_hi:[1,0,1] neg_lo:[0,1,0]
    v_cvt_pk_bf16_f32 v250, v70, v71
    v_cvt_pk_bf16_f32 v251, v64, v65
    ds_write_addtid_b32 v250 offset:4080
    ds_write_addtid_b32 v251 offset:4352
    v_pk_mul_f32 v[66:67], v[70:71], v[108:109] op_sel:[0,0] op_sel_hi:[0,1]
    v_pk_mul_f32 v[68:69], v[64:65], v[108:109] op_sel:[0,0] op_sel_hi:[0,1]
    v_pk_fma_f32 v[66:67], v[70:71], v[108:109], v[66:67] op_sel:[1,1,0] op_sel_hi:[1,0,1] neg_lo:[0,1,0]
    v_pk_fma_f32 v[68:69], v[64:65], v[108:109], v[68:69] op_sel:[1,1,0] op_sel_hi:[1,0,1] neg_lo:[0,1,0]
walk_2:
pad_kg_3:
    s_cbranch_execz pad_kg_4
    v_cvt_pk_bf16_f32 v248, v66, v67
    v_cvt_pk_bf16_f32 v249, v68, v69
    ds_write_addtid_b32 v248 offset:4624
    ds_write_addtid_b32 v249 offset:4896
    v_pk_mul_f32 v[70:71], v[66:67], v[108:109] op_sel:[0,0] op_sel_hi:[0,1]
    v_pk_mul_f32 v[64:65], v[68:69], v[108:109] op_sel:[0,0] op_sel_hi:[0,1]
    v_pk_fma_f32 v[70:71], v[66:67], v[108:109], v[70:71] op_sel:[1,1,0] op_sel_hi:[1,0,1] neg_lo:[0,1,0]
    v_pk_fma_f32 v[64:65], v[68:69], v[108:109], v[64:65] op_sel:[1,1,0] op_sel_hi:[1,0,1] neg_lo:[0,1,0]
    v_cvt_pk_bf16_f32 v250, v70, v71
    v_cvt_pk_bf16_f32 v251, v64, v65
    ds_write_addtid_b32 v250 offset:5168
    ds_write_addtid_b32 v251 offset:5440
    v_pk_mul_f32 v[66:67], v[70:71], v[108:109] op_sel:[0,0] op_sel_hi:[0,1]
    v_pk_mul_f32 v[68:69], v[64:65], v[108:109] op_sel:[0,0] op_sel_hi:[0,1]
    v_pk_fma_f32 v[66:67], v[70:71], v[108:109], v[66:67] op_sel:[1,1,0] op_sel_hi:[1,0,1] neg_lo:[0,1,0]
    v_pk_fma_f32 v[68:69], v[64:65], v[108:109], v[68:69] op_sel:[1,1,0] op_sel_hi:[1,0,1] neg_lo:[0,1,0]
    v_cvt_pk_bf16_f32 v248, v66, v67
    v_cvt_pk_bf16_f32 v249, v68, v69
    ds_write_addtid_b32 v248 offset:5712
    ds_write_addtid_b32 v249 offset:5984
    v_pk_mul_f32 v[70:71], v[66:67], v[108:109] op_sel:[0,0] op_sel_hi:[0,1]
    v_pk_mul_f32 v[64:65], v[68:69], v[108:109] op_sel:[0,0] op_sel_hi:[0,1]
    v_pk_fma_f32 v[70:71], v[66:67], v[108:109], v[70:71] op_sel:[1,1,0] op_sel_hi:[1,0,1] neg_lo:[0,1,0]
    v_pk_fma_f32 v[64:65], v[68:69], v[108:109], v[64:65] op_sel:[1,1,0] op_sel_hi:[1,0,1] neg_lo:[0,1,0]
    v_cvt_pk_bf16_f32 v250, v70, v71
    v_cvt_pk_bf16_f32 v251, v64, v65
    ds_write_addtid_b32 v250 offset:6256
    ds_write_addtid_b32 v251 offset:6528
    v_pk_mul_f32 v[66:67], v[70:71], v[108:109] op_sel:[0,0] op_sel_hi:[0,1]
    v_pk_mul_f32 v[68:69], v[64:65], v[108:109] op_sel:[0,0] op_sel_hi:[0,1]
    v_pk_fma_f32 v[66:67], v[70:71], v[108:109], v[66:67] op_sel:[1,1,0] op_sel_hi:[1,0,1] neg_lo:[0,1,0]
pad_kg_4:
    s_cbranch_execz pad_kg_5
    v_pk_fma_f32 v[68:69], v[64:65], v[108:109], v[68:69] op_sel:[1,1,0] op_sel_hi:[1,0,1] neg_lo:[0,1,0]
    v_cvt_pk_bf16_f32 v248, v66, v67
    v_cvt_pk_bf16_f32 v249, v68, v69
    ds_write_addtid_b32 v248 offset:6800
    ds_write_addtid_b32 v249 offset:7072
    v_pk_mul_f32 v[70:71], v[66:67], v[108:109] op_sel:[0,0] op_sel_hi:[0,1]
    v_pk_mul_f32 v[64:65], v[68:69], v[108:109] op_sel:[0,0] op_sel_hi:[0,1]
    v_pk_fma_f32 v[70:71], v[66:67], v[108:109], v[70:71] op_sel:[1,1,0] op_sel_hi:[1,0,1] neg_lo:[0,1,0]
    v_pk_fma_f32 v[64:65], v[68:69], v[108:109], v[64:65] op_sel:[1,1,0] op_sel_hi:[1,0,1] neg_lo:[0,1,0]
    v_cvt_pk_bf16_f32 v250, v70, v71
    v_cvt_pk_bf16_f32 v251, v64, v65
    ds_write_addtid_b32 v250 offset:7344
    ds_write_addtid_b32 v251 offset:7616
    v_pk_mul_f32 v[66:67], v[70:71], v[108:109] op_sel:[0,0] op_sel_hi:[0,1]
    v_pk_mul_f32 v[68:69], v[64:65], v[108:109] op_sel:[0,0] op_sel_hi:[0,1]
    v_pk_fma_f32 v[66:67], v[70:71], v[108:109], v[66:67] op_sel:[1,1,0] op_sel_hi:[1,0,1] neg_lo:[0,1,0]
    v_pk_fma_f32 v[68:69], v[64:65], v[108:109], v[68:69] op_sel:[1,1,0] op_sel_hi:[1,0,1] neg_lo:[0,1,0]
    v_cvt_pk_bf16_f32 v248, v66, v67
    v_cvt_pk_bf16_f32 v249, v68, v69
    ds_write_addtid_b32 v248 offset:7888
    ds_write_addtid_b32 v249 offset:8160
    v_pk_mul_f32 v[70:71], v[66:67], v[108:109] op_sel:[0,0] op_sel_hi:[0,1]
    v_pk_mul_f32 v[110:111], v[68:69], v[108:109] op_sel:[0,0] op_sel_hi:[0,1]
    v_pk_fma_f32 v[70:71], v[66:67], v[108:109], v[70:71] op_sel:[1,1,0] op_sel_hi:[1,0,1] neg_lo:[0,1,0]
    v_pk_fma_f32 v[110:111], v[68:69], v[108:109], v[110:111] op_sel:[1,1,0] op_sel_hi:[1,0,1] neg_lo:[0,1,0]
    v_cvt_pk_bf16_f32 v250, v70, v71
    ds_write_addtid_b32 v250 offset:8432
    ds_read_b128 v[32:35], v252 offset:0
    ds_read_b128 v[36:39], v252 offset:32
    ds_read_b128 v[40:43], v252 offset:64
    ds_read_b128 v[44:47], v252 offset:96
    ds_read_b128 v[48:51], v252 offset:128
pad_kg_5:
    s_cbranch_execz pad_gp_0
    ds_read_b128 v[52:55], v252 offset:160
    ds_read_b128 v[56:59], v252 offset:192
    ds_read_b128 v[60:63], v252 offset:224
    v_perm_b32 v96, v242, v242, s77
    v_perm_b32 v97, v243, v243, s77
    v_perm_b32 v98, v244, v244, s77
    v_perm_b32 v99, v245, v245, s77
    v_pk_mul_f32 v[96:97], v[96:97], v[246:247] op_sel_hi:[1,0]
    s_add_u32 s77, s77, 0x2020000
    v_pk_mul_f32 v[64:65], v[96:97], v[98:99] op_sel:[0,0] op_sel_hi:[0,1]
    v_pk_fma_f32 v[64:65], v[96:97], v[98:99], v[64:65] op_sel:[1,1,0] op_sel_hi:[1,0,1] neg_lo:[0,1,0]
    v_cvt_pk_bf16_f32 v248, v64, -v65
    ds_write_addtid_b32 v248 offset:0
    v_pk_mul_f32 v[66:67], v[64:65], v[104:105] op_sel:[0,0] op_sel_hi:[0,1]
    v_pk_mul_f32 v[68:69], v[64:65], v[110:111] op_sel:[0,0] op_sel_hi:[0,1]
    v_pk_fma_f32 v[66:67], v[64:65], v[104:105], v[66:67] op_sel:[1,1,0] op_sel_hi:[1,0,1] neg_lo:[0,1,0]
    v_pk_fma_f32 v[68:69], v[64:65], v[110:111], v[68:69] op_sel:[1,1,0] op_sel_hi:[1,0,1] neg_lo:[0,1,0]
    v_cvt_pk_bf16_f32 v250, v66, -v67
    v_cvt_pk_bf16_f32 v251, v68, -v69
    ds_write_addtid_b32 v250 offset:272
    ds_write_addtid_b32 v251 offset:2176
    ds_write_addtid_b32 v251 offset:3808
    v_pk_mul_f32 v[70:71], v[66:67], v[104:105] op_sel:[0,0] op_sel_hi:[0,1]
    v_pk_mul_f32 v[72:73], v[68:69], v[110:111] op_sel:[0,0] op_sel_hi:[0,1]
    v_pk_fma_f32 v[70:71], v[66:67], v[104:105], v[70:71] op_sel:[1,1,0] op_sel_hi:[1,0,1] neg_lo:[0,1,0]
    v_pk_fma_f32 v[72:73], v[68:69], v[110:111], v[72:73] op_sel:[1,1,0] op_sel_hi:[1,0,1] neg_lo:[0,1,0]
    v_cvt_pk_bf16_f32 v248, v70, -v71
    v_cvt_pk_bf16_f32 v249, v72, -v73
    ds_write_addtid_b32 v248 offset:544
    ds_write_addtid_b32 v249 offset:4352
    v_pk_mul_f32 v[74:75], v[70:71], v[104:105] op_sel:[0,0] op_sel_hi:[0,1]
pad_kg_6:
    s_cbranch_execz pad_kg_7
    v_pk_mul_f32 v[76:77], v[72:73], v[110:111] op_sel:[0,0] op_sel_hi:[0,1]
    v_pk_fma_f32 v[74:75], v[70:71], v[104:105], v[74:75] op_sel:[1,1,0] op_sel_hi:[1,0,1] neg_lo:[0,1,0]
    v_pk_fma_f32 v[76:77], v[72:73], v[110:111], v[76:77] op_sel:[1,1,0] op_sel_hi:[1,0,1] neg_lo:[0,1,0]
    v_cvt_pk_bf16_f32 v250, v74, -v75
    v_cvt_pk_bf16_f32 v251, v76, -v77
    ds_write_addtid_b32 v250 offset:816
    ds_write_addtid_b32 v251 offset:5440
    v_pk_mul_f32 v[78:79], v[74:75], v[104:105] op_sel:[0,0] op_sel_hi:[0,1]
    v_pk_mul_f32 v[80:81], v[76:77], v[110:111] op_sel:[0,0] op_sel_hi:[0,1]
    v_pk_fma_f32 v[78:79], v[74:75], v[104:105], v[78:79] op_sel:[1,1,0] op_sel_hi:[1,0,1] neg_lo:[0,1,0]
    v_pk_fma_f32 v[80:81], v[76:77], v[110:111], v[80:81] op_sel:[1,1,0] op_sel_hi:[1,0,1] neg_lo:[0,1,0]
    v_cvt_pk_bf16_f32 v248, v78, -v79
    v_cvt_pk_bf16_f32 v249, v80, -v81
    ds_write_addtid_b32 v248 offset:1088
    ds_write_addtid_b32 v249 offset:6528
    v_pk_mul_f32 v[82:83], v[78:79], v[104:105] op_sel:[0,0] op_sel_hi:[0,1]
    v_pk_mul_f32 v[84:85], v[80:81], v[110:111] op_sel:[0,0] op_sel_hi:[0,1]
    v_pk_fma_f32 v[82:83], v[78:79], v[104:105], v[82:83] op_sel:[1,1,0] op_sel_hi:[1,0,1] neg_lo:[0,1,0]
    v_pk_fma_f32 v[84:85], v[80:81], v[110:111], v[84:85] op_sel:[1,1,0] op_sel_hi:[1,0,1] neg_lo:[0,1,0]
    v_cvt_pk_bf16_f32 v250, v82, -v83
    v_cvt_pk_bf16_f32 v251, v84, -v85
    ds_write_addtid_b32 v250 offset:1360
    ds_write_addtid_b32 v251 offset:7616
    v_pk_mul_f32 v[86:87], v[82:83], v[104:105] op_sel:[0,0] op_sel_hi:[0,1]
    v_pk_mul_f32 v[88:89], v[84:85], v[110:111] op_sel:[0,0] op_sel_hi:[0,1]
    v_pk_fma_f32 v[86:87], v[82:83], v[104:105], v[86:87] op_sel:[1,1,0] op_sel_hi:[1,0,1] neg_lo:[0,1,0]
    v_pk_fma_f32 v[88:89], v[84:85], v[110:111], v[88:89] op_sel:[1,1,0] op_sel_hi:[1,0,1] neg_lo:[0,1,0]
    v_cvt_pk_bf16_f32 v248, v86, -v87
    v_cvt_pk_bf16_f32 v249, v88, -v89
    ds_write_addtid_b32 v248 offset:1632
    ds_write_addtid_b32 v249 offset:6800
    v_pk_mul_f32 v[90:91], v[86:87], v[104:105] op_sel:[0,0] op_sel_hi:[0,1]
pad_kg_7:
    s_cbranch_execz walk_done
    v_pk_mul_f32 v[92:93], v[78:79], v[110:111] op_sel:[0,0] op_sel_hi:[0,1]
    v_pk_fma_f32 v[90:91], v[86:87], v[104:105], v[90:91] op_sel:[1,1,0] op_sel_hi:[1,0,1] neg_lo:[0,1,0]
    v_pk_fma_f32 v[92:93], v[78:79], v[110:111], v[92:93] op_sel:[1,1,0] op_sel_hi:[1,0,1] neg_lo:[0,1,0]
    v_cvt_pk_bf16_f32 v250, v90, -v91
    v_cvt_pk_bf16_f32 v251, v92, -v93
    ds_write_addtid_b32 v250 offset:1904
    ds_write_addtid_b32 v251 offset:2720
    ds_write_addtid_b32 v251 offset:3264
    v_pk_mul_f32 v[94:95], v[88:89], v[110:111] op_sel:[0,0] op_sel_hi:[0,1]
    v_pk_mul_f32 v[64:65], v[92:93], v[110:111] op_sel:[0,0] op_sel_hi:[0,1]
    v_pk_fma_f32 v[94:95], v[88:89], v[110:111], v[94:95] op_sel:[1,1,0] op_sel_hi:[1,0,1] neg_lo:[0,1,0]
    v_pk_fma_f32 v[64:65], v[92:93], v[110:111], v[64:65] op_sel:[1,1,0] op_sel_hi:[1,0,1] neg_lo:[0,1,0]
    v_cvt_pk_bf16_f32 v248, v94, -v95
    v_cvt_pk_bf16_f32 v249, v64, -v65
    ds_write_addtid_b32 v248 offset:7888
    ds_write_addtid_b32 v249 offset:4624
    v_pk_mul_f32 v[66:67], v[94:95], v[110:111] op_sel:[0,0] op_sel_hi:[0,1]
    v_pk_mul_f32 v[68:69], v[64:65], v[110:111] op_sel:[0,0] op_sel_hi:[0,1]
    v_pk_fma_f32 v[66:67], v[94:95], v[110:111], v[66:67] op_sel:[1,1,0] op_sel_hi:[1,0,1] neg_lo:[0,1,0]
    v_pk_fma_f32 v[68:69], v[64:65], v[110:111], v[68:69] op_sel:[1,1,0] op_sel_hi:[1,0,1] neg_lo:[0,1,0]
    v_cvt_pk_bf16_f32 v250, v66, -v67
    v_cvt_pk_bf16_f32 v251, v68, -v69
    ds_write_addtid_b32 v250 offset:7072
    ds_write_addtid_b32 v251 offset:5712
    v_pk_mul_f32 v[72:73], v[70:71], v[110:111] op_sel:[0,0] op_sel_hi:[0,1]
    v_pk_mul_f32 v[74:75], v[86:87], v[110:111] op_sel:[0,0] op_sel_hi:[0,1]
    v_pk_fma_f32 v[72:73], v[70:71], v[110:111], v[72:73] op_sel:[1,1,0] op_sel_hi:[1,0,1] neg_lo:[0,1,0]
    v_pk_fma_f32 v[74:75], v[86:87], v[110:111], v[74:75] op_sel:[1,1,0] op_sel_hi:[1,0,1] neg_lo:[0,1,0]
    v_cvt_pk_bf16_f32 v248, v72, -v73
    v_cvt_pk_bf16_f32 v249, v74, -v75
    ds_write_addtid_b32 v248 offset:2448
pad_kg_8:
    s_cbranch_execz pad_kg_9
    ds_write_addtid_b32 v249 offset:3536
    ds_read_b128 v[64:67], v252 offset:0
    ds_read_b128 v[68:71], v252 offset:32
    ds_read_b128 v[72:75], v252 offset:64
    ds_read_b128 v[76:79], v252 offset:96
    ds_read_b128 v[80:83], v252 offset:128
    ds_read_b128 v[84:87], v252 offset:160
    ds_read_b128 v[88:91], v252 offset:192
    ds_read_b128 v[92:95], v252 offset:224
    s_sub_u32 s76, s76, 1
    s_cmp_eq_u32 s76, 0
    s_cbranch_scc1 kg_mm
    v_perm_b32 v96, v240, v240, s77
    v_perm_b32 v97, v241, v241, s77
    v_mul_f32 v96, v246, v96
    v_mul_f32 v97, v246, v97
    v_mul_f32 v96, 0x3fb8aa3b, v96
    v_mul_f32 v97, 0x3e22f983, v97
    v_mul_f32 v98, 0x41000000, v96
    v_mul_f32 v99, 0x41000000, v97
    v_fract_f32 v99, v99
    v_exp_f32 v98, v98
    v_cos_f32 v106, v99
    v_sin_f32 v107, v99
    v_fract_f32 v97, v97
    v_exp_f32 v96, v96
    v_cos_f32 v104, v97
    v_sin_f32 v105, v97
    v_pk_mul_f32 v[106:107], v[106:107], v[98:99] op_sel_hi:[1,0]
    v_pk_mul_f32 v[104:105], v[104:105], v[96:97] op_sel_hi:[1,0]
kg_mm:
    s_waitcnt lgkmcnt(7)
    v_mfma_f32_32x32x16_bf16 v[16:31], v[64:67], v[32:35], v[16:31]
    s_waitcnt lgkmcnt(6)
    v_mfma_f32_32x32x16_bf16 v[16:31], v[68:71], v[36:39], v[16:31]
    s_waitcnt lgkmcnt(5)
    v_mfma_f32_32x32x16_bf16 v[16:31], v[72:75], v[40:43], v[16:31]
    s_waitcnt lgkmcnt(4)
    v_mfma_f32_32x32x16_bf16 v[16:31], v[76:79], v[44:47], v[16:31]
    s_waitcnt lgkmcnt(3)
    v_mfma_f32_32x32x16_bf16 v[16:31], v[80:83], v[48:51], v[16:31]
    s_waitcnt lgkmcnt(2)
    v_mfma_f32_32x32x16_bf16 v[16:31], v[84:87], v[52:55], v[16:31]
pad_kg_9:
    s_cbranch_execz walk_done
    s_waitcnt lgkmcnt(1)
    v_mfma_f32_32x32x16_bf16 v[16:31], v[88:91], v[56:59], v[16:31]
    s_waitcnt lgkmcnt(0)
    v_mfma_f32_32x32x16_bf16 v[16:31], v[92:95], v[60:63], v[16:31]
    s_cbranch_scc0 kg_loop
    s_cmp_eq_u32 s15, 0
    s_cbranch_scc1 g_part
pad_sd_0:
    s_cbranch_execz pad_sd_1
    s_waitcnt vmcnt(0)
    s_mov_b32 s56, s40
    s_mov_b32 s57, s41
    s_mov_b32 s58, 0x21c000
    s_mov_b32 s59, 0x20000
    s_mul_i32 s3, s10, 27
    s_lshr_b32 s3, s3, 2
    s_mul_i32 s3, s3, 5
    s_sub_u32 s4, s11, 27
    s_lshl3_add_u32 s3, s4, s3
    s_add_u32 s3, s3, s6
    s_lshl_b32 s3, s3, 13
    v_lshlrev_b32 v98, 7, v1
    v_add_u32 v212, s3, v98
    buffer_load_dword v212, v212, s[56:59], 0 offen
    s_cmp_lt_u32 s6, 4
    s_cbranch_scc1 sd_exp
    s_cmp_lt_u32 s6, 6
    s_cbranch_scc1 sd_fin
    v_add_u32 v96, m0, v253
    ds_write_b128 v96, v[16:19] offset:0
    ds_write_b128 v96, v[20:23] offset:1024
    ds_write_b128 v96, v[24:27] offset:2048
    ds_write_b128 v96, v[28:31] offset:3072
    s_add_u32 s3, s50, 144
    v_mov_b32 v96, s3
    v_add_u32 v96, 163328, v96
    v_mov_b32 v97, 1
    ds_write_b32 v96, v97
    s_cmp_eq_u32 s6, 6
    s_cbranch_scc1 lw_side
spin_18:
    v_and_b32 v96, 7, v1
    v_lshlrev_b32 v96, 2, v96
    global_load_dword v96, v96, s[46:47] sc1
    s_waitcnt vmcnt(0)
    v_cmp_ne_u32 vcc, 1, v96
    s_nop 0
    s_cbranch_vccz spin_18_ok
    s_sleep 2
    s_sub_u32 s12, s12, 1
    s_cbranch_scc0 spin_18
pad_sd_1:
    s_cbranch_execz walk_done
    s_mov_b32 s12, 0
spin_18_ok:
    s_mul_i32 s3, s10, 5
    s_lshr_b32 s3, s3, 2
    s_lshl_b32 s3, s3, 10
    s_add_u32 s3, s3, 0xa50000
    v_lshrrev_b32 v96, 2, v1
    v_lshlrev_b32 v96, 5, v96
    v_and_or_b32 v96, v1, 3, v96
    v_lshlrev_b32 v96, 2, v96
spin_19:
    buffer_load_dword v97, v96, s[60:63], s3 offen sc1
    s_waitcnt vmcnt(0)
    v_cmp_ne_u32 vcc, 1, v97
    s_nop 0
    s_cbranch_vccz spin_19_ok
    s_sleep 4
    s_sub_u32 s12, s12, 1
    s_cbranch_scc0 spin_19
    s_mov_b32 s12, 0
spin_19_ok:
    v_mov_b32 v96, 163360
    v_mov_b32 v97, 1
    ds_write_b32 v96, v97
    s_sub_u32 s3, s11, 27
    s_mul_i32 s3, s3, 5
    v_add_u32 v96, s3, v1
    v_lshrrev_b32 v98, 2, v96
    v_and_b32 v96, 3, v96
    v_lshl_add_u32 v96, v96, 5, v98
    v_lshlrev_b32 v96, 7, v96
    s_and_b32 s3, s10, 1
    s_lshl_b32 s3, s3, 4
    s_lshr_b32 s4, s10, 1
    s_add_u32 s3, s3, s4
    s_lshl_b32 s3, s3, 10
    s_add_u32 s3, s3, 0xa48000
    s_mov_b64 exec, 31
    buffer_store_dword v97, v96, s[60:63], s3 offen sc1
    s_mov_b64 exec, -1
    s_branch sd_done
sd_fin:
    s_add_u32 s3, s50, 144
    v_mov_b32 v96, s3
    v_add_u32 v96, 163328, v96
spin_20:
    ds_read_b32 v97, v96
    s_waitcnt lgkmcnt(0)
    v_cmp_eq_u32 vcc, 0, v97
    s_nop 0
    s_cbranch_vccz spin_20_ok
    s_sub_u32 s12, s12, 1
    s_cbranch_scc0 spin_20
    s_mov_b32 s12, 0
spin_20_ok:
    s_add_u32 s3, m0, 17408
    v_add_u32 v96, s3, v253
walk_7:
pad_sd_2:
    s_cbranch_execz pad_sd_3
    ds_read_b128 v[32:35], v96 offset:0
    ds_read_b128 v[36:39], v96 offset:1024
    ds_read_b128 v[40:43], v96 offset:2048
    ds_read_b128 v[44:47], v96 offset:3072
    s_waitcnt lgkmcnt(3)
    v_add_f32 v16, v16, v32
    v_add_f32 v17, v17, v33
    v_add_f32 v18, v18, v34
    v_add_f32 v19, v19, v35
    s_waitcnt lgkmcnt(2)
    v_add_f32 v20, v20, v36
    v_add_f32 v21, v21, v37
    v_add_f32 v22, v22, v38
    v_add_f32 v23, v23, v39
    s_waitcnt lgkmcnt(1)
    v_add_f32 v24, v24, v40
    v_add_f32 v25, v25, v41
    v_add_f32 v26, v26, v42
    v_add_f32 v27, v27, v43
    s_waitcnt lgkmcnt(0)
    v_add_f32 v28, v28, v44
    v_add_f32 v29, v29, v45
    v_add_f32 v30, v30, v46
    v_add_f32 v31, v31, v47
sd_exp:
    v_lshlrev_b32 v247, 16, v247
    v_cmp_eq_u32 vcc, 0, v1
    s_nop 1
    v_cndmask_b32 v100, 0, v247, vcc
    v_and_b32 v101, 1, v1
    v_cmp_eq_u32 vcc, 0, v101
    v_mov_b32 v103, 0
    v_add_f32 v16, v16, v100
    v_mov_b32_dpp v23, v24 wave_rol:1 row_mask:0xf bank_mask:0xf
    s_nop 1
    v_mov_b32_dpp v23, v22 wave_shl:1 row_mask:0xf bank_mask:0xf
    v_mov_b32_dpp v26, v28 wave_rol:1 row_mask:0xf bank_mask:0xf
    s_nop 1
    v_mov_b32_dpp v26, v24 wave_shl:1 row_mask:0xf bank_mask:0xf
    v_mov_b32_dpp v27, v29 wave_rol:1 row_mask:0xf bank_mask:0xf
    s_nop 1
    v_mov_b32_dpp v27, v28 wave_shl:1 row_mask:0xf bank_mask:0xf
    v_mov_b32_dpp v31, v30 wave_rol:1 row_mask:0xf bank_mask:0xf
    s_nop 1
    v_mov_b32_dpp v31, v29 wave_shl:1 row_mask:0xf bank_mask:0xf
    v_mov_b32_dpp v22, v23 quad_perm:[0,1,2,3] row_mask:0xc bank_mask:0xf
    v_cvt_pk_bf16_f32 v32, v16, v17
    v_cvt_pk_bf16_f32 v33, v18, v19
    v_cvt_pk_bf16_f32 v34, v20, v20
pad_sd_3:
    s_cbranch_execz pad_sd_4
    v_cvt_pk_bf16_f32 v36, v24, v24
    v_cvt_pk_bf16_f32 v37, v24, v25
    v_cvt_pk_bf16_f32 v38, v25, v25
    v_cvt_pk_bf16_f32 v39, v26, v26
    v_cvt_pk_bf16_f32 v35, v21, v22
    v_cndmask_b32 v102, v27, v28, vcc
    v_cvt_pk_bf16_f32 v40, v28, v28
    v_cvt_pk_bf16_f32 v43, v27, v27
    v_cvt_pk_bf16_f32 v42, v102, v27
    v_mov_b32 v41, v40
    v_cndmask_b32 v102, v31, v29, vcc
    v_cvt_pk_bf16_f32 v44, v29, v29
    v_cvt_pk_bf16_f32 v47, v31, v31
    v_cvt_pk_bf16_f32 v46, v102, v31
    v_mov_b32 v45, v44
    v_permlane32_swap_b32 v32, v34
    v_permlane32_swap_b32 v33, v35
    s_nop 1
    v_mov_b32_dpp v103, v35 wave_shr:1 row_mask:0xf bank_mask:0xf
    v_alignbit_b32 v51, v35, v34, 16
    v_alignbit_b32 v50, v34, v33, 16
    v_alignbit_b32 v49, v33, v32, 16
    v_alignbit_b32 v48, v32, v103, 16
    v_mov_b32_dpp v103, v35 wave_ror:1 row_mask:0xf bank_mask:0xf
    s_nop 1
    v_mov_b32_dpp v103, v39 wave_shr:1 row_mask:0xf bank_mask:0xf
    v_alignbit_b32 v55, v39, v38, 16
    v_alignbit_b32 v54, v38, v37, 16
    v_alignbit_b32 v53, v37, v36, 16
    v_alignbit_b32 v52, v36, v103, 16
    v_mov_b32_dpp v103, v39 wave_ror:1 row_mask:0xf bank_mask:0xf
    s_nop 1
    v_mov_b32_dpp v103, v43 wave_shr:1 row_mask:0xf bank_mask:0xf
    v_alignbit_b32 v59, v43, v42, 16
    v_alignbit_b32 v58, v42, v41, 16
    v_alignbit_b32 v57, v41, v40, 16
pad_sd_4:
    s_cbranch_execz pad_sd_5
    v_alignbit_b32 v56, v40, v103, 16
    v_mov_b32_dpp v103, v43 wave_ror:1 row_mask:0xf bank_mask:0xf
    s_nop 1
    v_mov_b32_dpp v103, v47 wave_shr:1 row_mask:0xf bank_mask:0xf
    v_alignbit_b32 v63, v47, v46, 16
    v_alignbit_b32 v62, v46, v45, 16
    v_alignbit_b32 v61, v45, v44, 16
    v_alignbit_b32 v60, v44, v103, 16
    v_mov_b64 v[64:65], 0
    v_mov_b64 v[66:67], 0
    v_lshrrev_b32 v96, 1, v1
    v_mul_u32_u24 v96, 4160, v96
    v_lshl_add_u32 v96, v101, 4, v96
    v_add_u32 v97, s69, v253
    v_add_u32 v96, s69, v96
    ds_write_b128 v97, v[32:35] offset:32
    ds_write_b128 v97, v[48:51] offset:4192
    ds_write_b128 v97, v[36:39] offset:1056
    ds_write_b128 v97, v[52:55] offset:5216
    ds_write_b128 v97, v[40:43] offset:2080
    ds_write_b128 v97, v[56:59] offset:6240
    ds_write_b128 v97, v[44:47] offset:3104
    ds_write_b128 v97, v[60:63] offset:7264
    s_mov_b64 exec, 15
    ds_write_b128 v96, v[64:67]
    s_mov_b64 exec, -1
    v_lshrrev_b32 v96, 2, v1
    v_mul_u32_u24 v96, 40960, v96
    v_and_b32 v97, 3, v1
    v_lshl_add_u32 v96, v97, 4, v96
    v_add_u32 v98, s70, v253
    s_mov_b64 exec, 0x3fffffff
    ds_write_b128 v98, v[64:67] offset:4096
    s_mov_b64 exec, -1
lw_side:
    s_lshl_b32 s101, 1, s6
    s_cmp_eq_u32 s6, 6
    s_cselect_b32 s101, 0xc0, s101
    s_branch lw_go
lw_sback:
    s_cmp_eq_u32 s6, 6
pad_sd_5:
    s_cbranch_execz pad_sd_6
    s_cbranch_scc1 sd_done
    v_mov_b32 v100, 163360
spin_21:
    ds_read_b32 v101, v100
    s_waitcnt lgkmcnt(0)
    v_cmp_eq_u32 vcc, 0, v101
    s_nop 0
    s_cbranch_vccz spin_21_ok
    s_sleep 1
    s_sub_u32 s12, s12, 1
    s_cbranch_scc0 spin_21
    s_mov_b32 s12, 0
spin_21_ok:
    s_lshl_b32 s3, s68, 6
    s_add_u32 s3, s3, 0xc00000
    buffer_load_dwordx4 v[112:115], v96, s[60:63], s3 offen sc1
    s_add_u32 s3, s3, 655360
    buffer_load_dwordx4 v[116:119], v96, s[60:63], s3 offen sc1
    s_add_u32 s3, s3, 655360
    buffer_load_dwordx4 v[120:123], v96, s[60:63], s3 offen sc1
    s_add_u32 s3, s3, 655360
    buffer_load_dwordx4 v[124:127], v96, s[60:63], s3 offen sc1
    s_waitcnt vmcnt(3)
    ds_write_b128 v98, v[112:115] offset:0
    s_waitcnt vmcnt(2)
    ds_write_b128 v98, v[116:119] offset:1024
    s_waitcnt vmcnt(1)
    ds_write_b128 v98, v[120:123] offset:2048
    s_waitcnt vmcnt(0)
    ds_write_b128 v98, v[124:127] offset:3072
sd_done:
    v_and_b32 v10, 15, v1
    v_lshrrev_b32 v11, 4, v1
    v_lshlrev_b32 v8, 4, v11
    v_lshlrev_b32 v9, 5, v10
    v_sub_u32 v8, v8, v9
    v_add_u32 v8, 480, v8
    v_add_u32 v8, s70, v8
    v_and_b32 v4, 1, v11
    v_lshl_add_u32 v9, v4, 9, v9
    v_and_b32 v4, 2, v11
    v_lshl_add_u32 v9, v4, 3, v9
    s_lshl_b32 s3, s68, 12
    v_add_u32 v9, s3, v9
    v_lshrrev_b32 v4, 1, v10
    v_lshl_add_u32 v4, v11, 2, v4
    v_lshlrev_b32 v4, 2, v4
    v_and_b32 v10, 1, v10
pad_sd_6:
    s_cbranch_execz walk_done
    v_mul_u32_u24 v10, 4160, v10
    v_sub_u32 v4, v4, v10
    v_add_u32 v4, 4164, v4
    v_add_u32 v4, s69, v4
    v_add_u32 v5, 1024, v4
    v_add_u32 v6, 2048, v4
    v_add_u32 v7, 3072, v4
    s_waitcnt lgkmcnt(0)
    s_barrier
    s_mov_b32 s78, 1
    s_cmp_lt_u32 s6, 4
    s_cbranch_scc1 conv
    s_setprio 1
    s_branch conv
g_part:
pad_gp_0:
    s_cbranch_execz pad_gp_1
    v_add_u32 v96, m0, v253
    s_nop 7
    ds_write_b128 v96, v[16:19] offset:0
    ds_write_b128 v96, v[20:23] offset:1024
    ds_write_b128 v96, v[24:27] offset:2048
    ds_write_b128 v96, v[28:31] offset:3072
gemm:
    s_lshl2_add_u32 m0, s6, 161856
    s_mov_b64 vcc, 0
    s_waitcnt lgkmcnt(0)
    s_barrier
    ds_read_b64_tr_b16 v[48:49], v6 offset:0
    ds_read_b64_tr_b16 v[50:51], v6 offset:512
    ds_read_b64_tr_b16 v[52:53], v6 offset:4096
    ds_read_b64_tr_b16 v[54:55], v6 offset:4608
    ds_read_b128 v[16:19], v4 offset:0
    ds_read_b128 v[20:23], v5 offset:0
    ds_read_b64_tr_b16 v[56:57], v7 offset:0
    ds_read_b64_tr_b16 v[58:59], v7 offset:512
    ds_read_b64_tr_b16 v[60:61], v7 offset:4096
    ds_read_b64_tr_b16 v[62:63], v7 offset:4608
    ds_read_b64_tr_b16 v[64:65], v6 offset:8192
    ds_read_b64_tr_b16 v[66:67], v6 offset:8704
    ds_read_b64_tr_b16 v[68:69], v6 offset:12288
    ds_read_b64_tr_b16 v[70:71], v6 offset:12800
pad_gp_1:
    s_cbranch_execz walk_done
    s_waitcnt lgkmcnt(8)
    ds_read_b64_tr_b16 v[72:73], v7 offset:8192
    ds_read_b64_tr_b16 v[74:75], v7 offset:8704
    ds_read_b64_tr_b16 v[76:77], v7 offset:12288
    ds_read_b64_tr_b16 v[78:79], v7 offset:12800
    ds_read_b128 v[24:27], v4 offset:2048
    ds_read_b128 v[28:31], v5 offset:2048
    s_mov_b32 s76, 5
    s_waitcnt lgkmcnt(0)
g1_loop:
    s_waitcnt lgkmcnt(2)
    v_mfma_f32_16x16x32_bf16 v[112:115], v[48:51], v[16:19], v[112:115]
    ds_read_b128 v[32:35], v4 offset:4096
    v_mfma_f32_16x16x32_bf16 v[112:115], v[52:55], v[20:23], v[112:115]
    ds_read_b128 v[36:39], v5 offset:4096
    v_mfma_f32_16x16x32_bf16 v[116:119], v[56:59], v[16:19], v[116:119]
    v_mfma_f32_16x16x32_bf16 v[116:119], v[60:63], v[20:23], v[116:119]
    v_mfma_f32_16x16x32_bf16 v[176:179], v[64:67], v[16:19], v[176:179]
    v_mfma_f32_16x16x32_bf16 v[176:179], v[68:71], v[20:23], v[176:179]
    v_mfma_f32_16x16x32_bf16 v[180:183], v[72:75], v[16:19], v[180:183]
    v_mfma_f32_16x16x32_bf16 v[180:183], v[76:79], v[20:23], v[180:183]
    s_waitcnt lgkmcnt(2)
    v_mfma_f32_16x16x32_bf16 v[120:123], v[48:51], v[24:27], v[120:123]
    ds_read_b128 v[40:43], v4 offset:6144
    v_mfma_f32_16x16x32_bf16 v[120:123], v[52:55], v[28:31], v[120:123]
    ds_read_b128 v[44:47], v5 offset:6144
    v_mfma_f32_16x16x32_bf16 v[124:127], v[56:59], v[24:27], v[124:127]
    v_mfma_f32_16x16x32_bf16 v[124:127], v[60:63], v[28:31], v[124:127]
    v_mfma_f32_16x16x32_bf16 v[184:187], v[64:67], v[24:27], v[184:187]
    v_mfma_f32_16x16x32_bf16 v[184:187], v[68:71], v[28:31], v[184:187]
    v_mfma_f32_16x16x32_bf16 v[188:191], v[72:75], v[24:27], v[188:191]
    v_mfma_f32_16x16x32_bf16 v[188:191], v[76:79], v[28:31], v[188:191]
    s_waitcnt lgkmcnt(0)
    v_mfma_f32_16x16x32_bf16 v[128:131], v[48:51], v[32:35], v[128:131]
    s_barrier
    ds_read_b128 v[16:19], v4 offset:16384
    v_mfma_f32_16x16x32_bf16 v[128:131], v[52:55], v[36:39], v[128:131]
    ds_read_b128 v[20:23], v5 offset:16384
    v_mfma_f32_16x16x32_bf16 v[132:135], v[56:59], v[32:35], v[132:135]
    ds_read_b64_tr_b16 v[80:81], v6 offset:16384
    v_mfma_f32_16x16x32_bf16 v[132:135], v[60:63], v[36:39], v[132:135]
    ds_read_b64_tr_b16 v[82:83], v6 offset:16896
    v_mfma_f32_16x16x32_bf16 v[192:195], v[64:67], v[32:35], v[192:195]
    ds_read_b64_tr_b16 v[84:85], v6 offset:20480
    v_mfma_f32_16x16x32_bf16 v[192:195], v[68:71], v[36:39], v[192:195]
    ds_read_b64_tr_b16 v[86:87], v6 offset:20992
    v_mfma_f32_16x16x32_bf16 v[196:199], v[72:75], v[32:35], v[196:199]
    v_mfma_f32_16x16x32_bf16 v[196:199], v[76:79], v[36:39], v[196:199]
    v_mfma_f32_16x16x32_bf16 v[136:139], v[48:51], v[40:43], v[136:139]
    ds_read_b128 v[24:27], v4 offset:18432
    v_mfma_f32_16x16x32_bf16 v[136:139], v[52:55], v[44:47], v[136:139]
    ds_read_b128 v[28:31], v5 offset:18432
    v_mfma_f32_16x16x32_bf16 v[140:143], v[56:59], v[40:43], v[140:143]
    ds_read_b64_tr_b16 v[88:89], v7 offset:16384
    v_mfma_f32_16x16x32_bf16 v[140:143], v[60:63], v[44:47], v[140:143]
    ds_read_b64_tr_b16 v[90:91], v7 offset:16896
    v_mfma_f32_16x16x32_bf16 v[200:203], v[64:67], v[40:43], v[200:203]
    ds_read_b64_tr_b16 v[92:93], v7 offset:20480
    v_mfma_f32_16x16x32_bf16 v[200:203], v[68:71], v[44:47], v[200:203]
    ds_read_b64_tr_b16 v[94:95], v7 offset:20992
    v_mfma_f32_16x16x32_bf16 v[204:207], v[72:75], v[40:43], v[204:207]
    v_mfma_f32_16x16x32_bf16 v[204:207], v[76:79], v[44:47], v[204:207]
    s_waitcnt lgkmcnt(10)
    v_mfma_f32_16x16x32_bf16 v[144:147], v[48:51], v[16:19], v[144:147]
    ds_read_b128 v[32:35], v4 offset:20480
    v_mfma_f32_16x16x32_bf16 v[144:147], v[52:55], v[20:23], v[144:147]
    ds_read_b128 v[36:39], v5 offset:20480
    v_mfma_f32_16x16x32_bf16 v[148:151], v[56:59], v[16:19], v[148:151]
    ds_read_b64_tr_b16 v[96:97], v6 offset:24576
    v_mfma_f32_16x16x32_bf16 v[148:151], v[60:63], v[20:23], v[148:151]
    ds_read_b64_tr_b16 v[98:99], v6 offset:25088
    v_mfma_f32_16x16x32_bf16 v[208:211], v[64:67], v[16:19], v[208:211]
    ds_read_b64_tr_b16 v[100:101], v6 offset:28672
    v_mfma_f32_16x16x32_bf16 v[208:211], v[68:71], v[20:23], v[208:211]
    ds_read_b64_tr_b16 v[102:103], v6 offset:29184
    v_mfma_f32_16x16x32_bf16 v[212:215], v[72:75], v[16:19], v[212:215]
    v_mfma_f32_16x16x32_bf16 v[212:215], v[76:79], v[20:23], v[212:215]
    s_waitcnt lgkmcnt(10)
    v_mfma_f32_16x16x32_bf16 v[152:155], v[48:51], v[24:27], v[152:155]
    ds_read_b32 v10, v9 offset:32
    v_mfma_f32_16x16x32_bf16 v[152:155], v[52:55], v[28:31], v[152:155]
    ds_read_b128 v[40:43], v4 offset:22528
    v_mfma_f32_16x16x32_bf16 v[156:159], v[56:59], v[24:27], v[156:159]
    ds_read_b128 v[44:47], v5 offset:22528
    v_mfma_f32_16x16x32_bf16 v[156:159], v[60:63], v[28:31], v[156:159]
    ds_read_b64_tr_b16 v[104:105], v7 offset:24576
    v_mfma_f32_16x16x32_bf16 v[216:219], v[64:67], v[24:27], v[216:219]
    ds_read_b64_tr_b16 v[106:107], v7 offset:25088
    v_mfma_f32_16x16x32_bf16 v[216:219], v[68:71], v[28:31], v[216:219]
    ds_read_b64_tr_b16 v[108:109], v7 offset:28672
    v_mfma_f32_16x16x32_bf16 v[220:223], v[72:75], v[24:27], v[220:223]
    ds_read_b64_tr_b16 v[110:111], v7 offset:29184
    v_mfma_f32_16x16x32_bf16 v[220:223], v[76:79], v[28:31], v[220:223]
    s_waitcnt lgkmcnt(0)
    v_mfma_f32_16x16x32_bf16 v[160:163], v[48:51], v[32:35], v[160:163]
    s_cbranch_vccnz g1_alt1
    s_barrier
g1_back1:
    ds_read_b128 v[16:19], v4 offset:32768
    v_mfma_f32_16x16x32_bf16 v[160:163], v[52:55], v[36:39], v[160:163]
    ds_read_b128 v[20:23], v5 offset:32768
    v_mfma_f32_16x16x32_bf16 v[164:167], v[56:59], v[32:35], v[164:167]
    v_mfma_f32_16x16x32_bf16 v[164:167], v[60:63], v[36:39], v[164:167]
    v_mfma_f32_16x16x32_bf16 v[224:227], v[64:67], v[32:35], v[224:227]
    v_mfma_f32_16x16x32_bf16 v[224:227], v[68:71], v[36:39], v[224:227]
    v_mfma_f32_16x16x32_bf16 v[228:231], v[72:75], v[32:35], v[228:231]
    v_mfma_f32_16x16x32_bf16 v[228:231], v[76:79], v[36:39], v[228:231]
    v_mfma_f32_16x16x32_bf16 v[168:171], v[48:51], v[40:43], v[168:171]
    ds_read_b128 v[24:27], v4 offset:34816
    v_mfma_f32_16x16x32_bf16 v[168:171], v[52:55], v[44:47], v[168:171]
    ds_read_b128 v[28:31], v5 offset:34816
    v_mfma_f32_16x16x32_bf16 v[172:175], v[56:59], v[40:43], v[172:175]
    v_mfma_f32_16x16x32_bf16 v[172:175], v[60:63], v[44:47], v[172:175]
    v_mfma_f32_16x16x32_bf16 v[232:235], v[64:67], v[40:43], v[232:235]
    v_mfma_f32_16x16x32_bf16 v[232:235], v[68:71], v[44:47], v[232:235]
    v_mfma_f32_16x16x32_bf16 v[236:239], v[72:75], v[40:43], v[236:239]
    v_mfma_f32_16x16x32_bf16 v[236:239], v[76:79], v[44:47], v[236:239]
    s_waitcnt lgkmcnt(2)
    v_mfma_f32_16x16x32_bf16 v[112:115], v[80:83], v[16:19], v[112:115]
    ds_read_b128 v[32:35], v4 offset:36864
    v_mfma_f32_16x16x32_bf16 v[112:115], v[84:87], v[20:23], v[112:115]
    ds_read_b128 v[36:39], v5 offset:36864
    v_mfma_f32_16x16x32_bf16 v[116:119], v[88:91], v[16:19], v[116:119]
    v_mfma_f32_16x16x32_bf16 v[116:119], v[92:95], v[20:23], v[116:119]
    v_mfma_f32_16x16x32_bf16 v[176:179], v[96:99], v[16:19], v[176:179]
    v_mfma_f32_16x16x32_bf16 v[176:179], v[100:103], v[20:23], v[176:179]
    v_mfma_f32_16x16x32_bf16 v[180:183], v[104:107], v[16:19], v[180:183]
    v_mfma_f32_16x16x32_bf16 v[180:183], v[108:111], v[20:23], v[180:183]
    s_waitcnt lgkmcnt(2)
    v_mfma_f32_16x16x32_bf16 v[120:123], v[80:83], v[24:27], v[120:123]
    ds_read_b128 v[40:43], v4 offset:38912
    v_mfma_f32_16x16x32_bf16 v[120:123], v[84:87], v[28:31], v[120:123]
    ds_read_b128 v[44:47], v5 offset:38912
    v_mfma_f32_16x16x32_bf16 v[124:127], v[88:91], v[24:27], v[124:127]
    v_mfma_f32_16x16x32_bf16 v[124:127], v[92:95], v[28:31], v[124:127]
    v_mfma_f32_16x16x32_bf16 v[184:187], v[96:99], v[24:27], v[184:187]
    v_mfma_f32_16x16x32_bf16 v[184:187], v[100:103], v[28:31], v[184:187]
    v_mfma_f32_16x16x32_bf16 v[188:191], v[104:107], v[24:27], v[188:191]
    v_mfma_f32_16x16x32_bf16 v[188:191], v[108:111], v[28:31], v[188:191]
    s_waitcnt lgkmcnt(0)
    v_mfma_f32_16x16x32_bf16 v[128:131], v[80:83], v[32:35], v[128:131]
    s_cbranch_vccnz g1_back2
    s_barrier
g1_back2:
    ds_read_b128 v[16:19], v4 offset:49152
    v_mfma_f32_16x16x32_bf16 v[128:131], v[84:87], v[36:39], v[128:131]
    ds_read_b128 v[20:23], v5 offset:49152
    v_mfma_f32_16x16x32_bf16 v[132:135], v[88:91], v[32:35], v[132:135]
    ds_read_b64_tr_b16 v[48:49], v6 offset:0
    v_mfma_f32_16x16x32_bf16 v[132:135], v[92:95], v[36:39], v[132:135]
    ds_read_b64_tr_b16 v[50:51], v6 offset:512
    v_mfma_f32_16x16x32_bf16 v[192:195], v[96:99], v[32:35], v[192:195]
    ds_read_b64_tr_b16 v[52:53], v6 offset:4096
    v_mfma_f32_16x16x32_bf16 v[192:195], v[100:103], v[36:39], v[192:195]
    ds_read_b64_tr_b16 v[54:55], v6 offset:4608
    v_mfma_f32_16x16x32_bf16 v[196:199], v[104:107], v[32:35], v[196:199]
    v_mfma_f32_16x16x32_bf16 v[196:199], v[108:111], v[36:39], v[196:199]
    v_mfma_f32_16x16x32_bf16 v[136:139], v[80:83], v[40:43], v[136:139]
    ds_read_b128 v[24:27], v4 offset:51200
    v_mfma_f32_16x16x32_bf16 v[136:139], v[84:87], v[44:47], v[136:139]
    ds_read_b128 v[28:31], v5 offset:51200
    v_mfma_f32_16x16x32_bf16 v[140:143], v[88:91], v[40:43], v[140:143]
    ds_read_b64_tr_b16 v[56:57], v7 offset:0
    v_mfma_f32_16x16x32_bf16 v[140:143], v[92:95], v[44:47], v[140:143]
    ds_read_b64_tr_b16 v[58:59], v7 offset:512
    v_mfma_f32_16x16x32_bf16 v[200:203], v[96:99], v[40:43], v[200:203]
    ds_read_b64_tr_b16 v[60:61], v7 offset:4096
    v_mfma_f32_16x16x32_bf16 v[200:203], v[100:103], v[44:47], v[200:203]
    ds_read_b64_tr_b16 v[62:63], v7 offset:4608
    v_mfma_f32_16x16x32_bf16 v[204:207], v[104:107], v[40:43], v[204:207]
    v_mfma_f32_16x16x32_bf16 v[204:207], v[108:111], v[44:47], v[204:207]
    s_cbranch_vccnz g1_epi
    s_waitcnt lgkmcnt(10)
    v_mfma_f32_16x16x32_bf16 v[144:147], v[80:83], v[16:19], v[144:147]
    ds_read_b128 v[32:35], v4 offset:53248
    v_mfma_f32_16x16x32_bf16 v[144:147], v[84:87], v[20:23], v[144:147]
    ds_read_b128 v[36:39], v5 offset:53248
    v_mfma_f32_16x16x32_bf16 v[148:151], v[88:91], v[16:19], v[148:151]
    ds_read_b64_tr_b16 v[64:65], v6 offset:8192
    v_mfma_f32_16x16x32_bf16 v[148:151], v[92:95], v[20:23], v[148:151]
    ds_read_b64_tr_b16 v[66:67], v6 offset:8704
    v_mfma_f32_16x16x32_bf16 v[208:211], v[96:99], v[16:19], v[208:211]
    ds_read_b64_tr_b16 v[68:69], v6 offset:12288
    v_mfma_f32_16x16x32_bf16 v[208:211], v[100:103], v[20:23], v[208:211]
    ds_read_b64_tr_b16 v[70:71], v6 offset:12800
    v_mfma_f32_16x16x32_bf16 v[212:215], v[104:107], v[16:19], v[212:215]
    v_mfma_f32_16x16x32_bf16 v[212:215], v[108:111], v[20:23], v[212:215]
    s_waitcnt lgkmcnt(10)
    v_mfma_f32_16x16x32_bf16 v[152:155], v[80:83], v[24:27], v[152:155]
    ds_read_b128 v[40:43], v4 offset:55296
    v_mfma_f32_16x16x32_bf16 v[152:155], v[84:87], v[28:31], v[152:155]
    ds_read_b128 v[44:47], v5 offset:55296
    v_mfma_f32_16x16x32_bf16 v[156:159], v[88:91], v[24:27], v[156:159]
    ds_read_b64_tr_b16 v[72:73], v7 offset:8192
    v_mfma_f32_16x16x32_bf16 v[156:159], v[92:95], v[28:31], v[156:159]
    ds_read_b64_tr_b16 v[74:75], v7 offset:8704
    v_mfma_f32_16x16x32_bf16 v[216:219], v[96:99], v[24:27], v[216:219]
    ds_read_b64_tr_b16 v[76:77], v7 offset:12288
    v_mfma_f32_16x16x32_bf16 v[216:219], v[100:103], v[28:31], v[216:219]
    ds_read_b64_tr_b16 v[78:79], v7 offset:12800
    v_mfma_f32_16x16x32_bf16 v[220:223], v[104:107], v[24:27], v[220:223]
    v_mfma_f32_16x16x32_bf16 v[220:223], v[108:111], v[28:31], v[220:223]
    s_waitcnt lgkmcnt(0)
    v_mfma_f32_16x16x32_bf16 v[160:163], v[80:83], v[32:35], v[160:163]
    s_cbranch_vccnz g1_back3
    s_barrier
g1_back3:
    ds_read_b128 v[16:19], v4 offset:0
    v_mfma_f32_16x16x32_bf16 v[160:163], v[84:87], v[36:39], v[160:163]
    ds_read_b128 v[20:23], v5 offset:0
    v_mfma_f32_16x16x32_bf16 v[164:167], v[88:91], v[32:35], v[164:167]
    v_mfma_f32_16x16x32_bf16 v[164:167], v[92:95], v[36:39], v[164:167]
    v_mfma_f32_16x16x32_bf16 v[224:227], v[96:99], v[32:35], v[224:227]
    v_mfma_f32_16x16x32_bf16 v[224:227], v[100:103], v[36:39], v[224:227]
    v_mfma_f32_16x16x32_bf16 v[228:231], v[104:107], v[32:35], v[228:231]
    v_mfma_f32_16x16x32_bf16 v[228:231], v[108:111], v[36:39], v[228:231]
    v_mfma_f32_16x16x32_bf16 v[168:171], v[80:83], v[40:43], v[168:171]
    ds_read_b128 v[24:27], v4 offset:2048
    v_mfma_f32_16x16x32_bf16 v[168:171], v[84:87], v[44:47], v[168:171]
    ds_read_b128 v[28:31], v5 offset:2048
    v_mfma_f32_16x16x32_bf16 v[172:175], v[88:91], v[40:43], v[172:175]
    v_mfma_f32_16x16x32_bf16 v[172:175], v[92:95], v[44:47], v[172:175]
    v_mfma_f32_16x16x32_bf16 v[232:235], v[96:99], v[40:43], v[232:235]
    s_cmp_eq_u32 s76, 2
    s_cselect_b64 vcc, -1, 0
    v_mfma_f32_16x16x32_bf16 v[232:235], v[100:103], v[44:47], v[232:235]
    s_sub_u32 s76, s76, 1
    v_mfma_f32_16x16x32_bf16 v[236:239], v[104:107], v[40:43], v[236:239]
    v_mfma_f32_16x16x32_bf16 v[236:239], v[108:111], v[44:47], v[236:239]
    s_branch g1_loop
g1_alt1:
    v_cmp_ne_u32 vcc, 0, v10
    s_nop 0
    s_cbranch_vccz g1_ok1
spin_22:
    ds_read_b32 v10, v9 offset:32
    s_waitcnt lgkmcnt(0)
    v_cmp_ne_u32 vcc, 0, v10
    s_nop 0
    s_cbranch_vccz spin_22_ok
    s_sub_u32 s12, s12, 1
    s_cbranch_scc0 spin_22
    s_mov_b32 s12, 0
spin_22_ok:
g1_ok1:
    s_mov_b64 vcc, -1
    s_branch g1_back1
g1_epi:
walk_10:
pad_ep_0:
    s_cbranch_execz pad_ep_1
    s_waitcnt lgkmcnt(10)
    v_mfma_f32_16x16x32_bf16 v[144:147], v[80:83], v[16:19], v[144:147]
    ds_read_b128 v[32:35], v4 offset:53248
    s_and_b32 s3, s6, 1
    s_lshl_b32 s4, s7, 1
pad_ep_1:
    s_cbranch_execz pad_ep_2
    s_add_u32 s3, s3, s4
    v_mfma_f32_16x16x32_bf16 v[144:147], v[84:87], v[20:23], v[144:147]
    ds_read_b128 v[36:39], v5 offset:53248
    s_mul_i32 s3, s3, 108
    s_lshl_b32 s4, s8, 1
    s_add_u32 s3, s3, s4
    s_lshr_b32 s4, s6, 1
    v_mfma_f32_16x16x32_bf16 v[148:151], v[88:91], v[16:19], v[148:151]
    s_add_u32 s3, s3, s4
    s_lshl_b32 s4, s3, 12
    s_add_u32 s5, s4, 221184
    v_mul_f32 v112, v112, v176
    v_mfma_f32_16x16x32_bf16 v[148:151], v[92:95], v[20:23], v[148:151]
    v_mul_f32 v113, v113, v177
    v_mul_f32 v114, v114, v178
    v_mul_f32 v115, v115, v179
    v_mul_f32 v116, v116, v180
    v_mfma_f32_16x16x32_bf16 v[208:211], v[96:99], v[16:19], v[208:211]
    v_mul_f32 v117, v117, v181
    v_mul_f32 v118, v118, v182
    v_mul_f32 v119, v119, v183
    v_mfma_f32_16x16x32_bf16 v[208:211], v[100:103], v[20:23], v[208:211]
    s_waitcnt lgkmcnt(2)
pad_ep_2:
    s_cbranch_execz pad_ep_3
    v_cvt_pk_bf16_f32 v48, v112, v113
    v_cvt_pk_bf16_f32 v49, v114, v115
    v_cvt_pk_bf16_f32 v50, v116, v117
    v_mfma_f32_16x16x32_bf16 v[212:215], v[104:107], v[16:19], v[212:215]
    v_cvt_pk_bf16_f32 v51, v118, v119
    buffer_store_dwordx4 v[48:51], v8, s[60:63], s4 offen offset:0 sc1
    v_mul_f32 v120, v120, v184
    v_mul_f32 v121, v121, v185
    v_mfma_f32_16x16x32_bf16 v[212:215], v[108:111], v[20:23], v[212:215]
    v_mul_f32 v122, v122, v186
    v_mul_f32 v123, v123, v187
    v_mul_f32 v124, v124, v188
    v_mul_f32 v125, v125, v189
    v_mfma_f32_16x16x32_bf16 v[152:155], v[80:83], v[24:27], v[152:155]
    ds_read_b128 v[40:43], v4 offset:55296
    v_mul_f32 v126, v126, v190
    v_mul_f32 v127, v127, v191
    v_cvt_pk_bf16_f32 v52, v120, v121
    v_mfma_f32_16x16x32_bf16 v[152:155], v[84:87], v[28:31], v[152:155]
    ds_read_b128 v[44:47], v5 offset:55296
pad_ep_3:
    s_cbranch_execz pad_ep_4
    v_cvt_pk_bf16_f32 v53, v122, v123
    v_cvt_pk_bf16_f32 v54, v124, v125
    v_cvt_pk_bf16_f32 v55, v126, v127
    buffer_store_dwordx4 v[52:55], v8, s[60:63], s4 offen offset:1024 sc1
    v_mfma_f32_16x16x32_bf16 v[156:159], v[88:91], v[24:27], v[156:159]
    v_mul_f32 v128, v128, v192
    v_mul_f32 v129, v129, v193
    v_mul_f32 v130, v130, v194
    v_mfma_f32_16x16x32_bf16 v[156:159], v[92:95], v[28:31], v[156:159]
    v_mul_f32 v131, v131, v195
    v_mul_f32 v132, v132, v196
    v_mul_f32 v133, v133, v197
    v_mul_f32 v134, v134, v198
    v_mfma_f32_16x16x32_bf16 v[216:219], v[96:99], v[24:27], v[216:219]
    v_mul_f32 v135, v135, v199
    v_cvt_pk_bf16_f32 v56, v128, v129
    v_cvt_pk_bf16_f32 v57, v130, v131
    v_mfma_f32_16x16x32_bf16 v[216:219], v[100:103], v[28:31], v[216:219]
    v_cvt_pk_bf16_f32 v58, v132, v133
pad_ep_4:
    s_cbranch_execz pad_ep_5
    v_cvt_pk_bf16_f32 v59, v134, v135
    buffer_store_dwordx4 v[56:59], v8, s[60:63], s4 offen offset:2048 sc1
    v_mul_f32 v136, v136, v200
    v_mfma_f32_16x16x32_bf16 v[220:223], v[104:107], v[24:27], v[220:223]
    v_mul_f32 v137, v137, v201
    v_mul_f32 v138, v138, v202
    v_mul_f32 v139, v139, v203
    v_mfma_f32_16x16x32_bf16 v[220:223], v[108:111], v[28:31], v[220:223]
    v_mul_f32 v140, v140, v204
    v_mul_f32 v141, v141, v205
    v_mul_f32 v142, v142, v206
    v_mul_f32 v143, v143, v207
    s_waitcnt lgkmcnt(2)
    v_mfma_f32_16x16x32_bf16 v[160:163], v[80:83], v[32:35], v[160:163]
    v_cvt_pk_bf16_f32 v60, v136, v137
    v_cvt_pk_bf16_f32 v61, v138, v139
    v_cvt_pk_bf16_f32 v62, v140, v141
    v_mfma_f32_16x16x32_bf16 v[160:163], v[84:87], v[36:39], v[160:163]
    v_cvt_pk_bf16_f32 v63, v142, v143
    buffer_store_dwordx4 v[60:63], v8, s[60:63], s4 offen offset:3072 sc1
pad_ep_5:
    s_cbranch_execz pad_ep_6
    v_mul_f32 v144, v144, v208
    v_mfma_f32_16x16x32_bf16 v[164:167], v[88:91], v[32:35], v[164:167]
    v_mul_f32 v145, v145, v209
    v_mul_f32 v146, v146, v210
    v_mul_f32 v147, v147, v211
    v_mfma_f32_16x16x32_bf16 v[164:167], v[92:95], v[36:39], v[164:167]
    v_mul_f32 v148, v148, v212
    v_mul_f32 v149, v149, v213
    v_mul_f32 v150, v150, v214
    v_mfma_f32_16x16x32_bf16 v[224:227], v[96:99], v[32:35], v[224:227]
    v_mul_f32 v151, v151, v215
    v_cvt_pk_bf16_f32 v64, v144, v145
    v_cvt_pk_bf16_f32 v65, v146, v147
    v_mfma_f32_16x16x32_bf16 v[224:227], v[100:103], v[36:39], v[224:227]
    v_cvt_pk_bf16_f32 v66, v148, v149
    v_cvt_pk_bf16_f32 v67, v150, v151
    buffer_store_dwordx4 v[64:67], v8, s[60:63], s5 offen offset:0 sc1
    v_mfma_f32_16x16x32_bf16 v[228:231], v[104:107], v[32:35], v[228:231]
    v_mul_f32 v152, v152, v216
    v_mul_f32 v153, v153, v217
    v_mul_f32 v154, v154, v218
pad_ep_6:
    s_cbranch_execz pad_ep_7
    v_mfma_f32_16x16x32_bf16 v[228:231], v[108:111], v[36:39], v[228:231]
    v_mul_f32 v155, v155, v219
    v_mul_f32 v156, v156, v220
    v_mul_f32 v157, v157, v221
    s_waitcnt lgkmcnt(0)
    v_mfma_f32_16x16x32_bf16 v[168:171], v[80:83], v[40:43], v[168:171]
    v_mul_f32 v158, v158, v222
    v_mul_f32 v159, v159, v223
    v_mfma_f32_16x16x32_bf16 v[168:171], v[84:87], v[44:47], v[168:171]
    v_cvt_pk_bf16_f32 v68, v152, v153
    v_cvt_pk_bf16_f32 v69, v154, v155
    v_cvt_pk_bf16_f32 v70, v156, v157
    v_mfma_f32_16x16x32_bf16 v[172:175], v[88:91], v[40:43], v[172:175]
    v_cvt_pk_bf16_f32 v71, v158, v159
    buffer_store_dwordx4 v[68:71], v8, s[60:63], s5 offen offset:1024 sc1
    v_mfma_f32_16x16x32_bf16 v[172:175], v[92:95], v[44:47], v[172:175]
    v_mul_f32 v160, v160, v224
    v_mul_f32 v161, v161, v225
    v_mul_f32 v162, v162, v226
    v_mfma_f32_16x16x32_bf16 v[232:235], v[96:99], v[40:43], v[232:235]
pad_ep_7:
    s_cbranch_execz pad_ep_8
    v_mul_f32 v163, v163, v227
    v_mul_f32 v164, v164, v228
    v_mfma_f32_16x16x32_bf16 v[232:235], v[100:103], v[44:47], v[232:235]
    v_mul_f32 v165, v165, v229
    v_mul_f32 v166, v166, v230
    v_mul_f32 v167, v167, v231
    v_mfma_f32_16x16x32_bf16 v[236:239], v[104:107], v[40:43], v[236:239]
    v_cvt_pk_bf16_f32 v72, v160, v161
    v_cvt_pk_bf16_f32 v73, v162, v163
    v_mfma_f32_16x16x32_bf16 v[236:239], v[108:111], v[44:47], v[236:239]
    v_cvt_pk_bf16_f32 v74, v164, v165
    v_cvt_pk_bf16_f32 v75, v166, v167
    buffer_store_dwordx4 v[72:75], v8, s[60:63], s5 offen offset:2048 sc1
    v_mul_f32 v168, v168, v232
    v_mul_f32 v169, v169, v233
    v_mul_f32 v170, v170, v234
    v_mul_f32 v171, v171, v235
    s_nop 0
    v_mul_f32 v172, v172, v236
    v_mul_f32 v173, v173, v237
    v_mul_f32 v174, v174, v238
    v_mul_f32 v175, v175, v239
    v_cvt_pk_bf16_f32 v76, v168, v169
pad_ep_8:
    s_cbranch_execz pad_ep_9
    v_cvt_pk_bf16_f32 v77, v170, v171
    v_cvt_pk_bf16_f32 v78, v172, v173
    v_cvt_pk_bf16_f32 v79, v174, v175
    buffer_store_dwordx4 v[76:79], v8, s[60:63], s5 offen offset:3072 sc1
    v_mov_b32 v11, m0
    v_mov_b32 v12, 0
    s_mov_b64 exec, 1
    ds_write_b32 v11, v12
    s_mov_b64 exec, -1
    s_and_b32 s3, s6, 1
    s_lshl1_add_u32 s3, s7, s3
    s_lshr_b32 s4, s6, 1
    s_lshl1_add_u32 s4, s8, s4
    s_lshl_b32 s3, s3, 7
    s_add_u32 s3, s3, s4
    s_cmp_ge_u32 s4, 14
    s_cselect_b32 s5, 18, 0
    s_add_u32 s3, s3, s5
    s_cmp_ge_u32 s4, 28
    s_cselect_b32 s5, 18, 0
    s_add_u32 s3, s3, s5
    s_cmp_ge_u32 s4, 41
    s_cselect_b32 s5, 19, 0
    s_add_u32 s3, s3, s5
    s_lshl2_add_u32 s76, s3, 0xa40000
pad_ep_9:
    s_cbranch_execz pad_ep_10
    v_and_b32 v10, 15, v1
    v_lshrrev_b32 v11, 4, v1
    v_lshlrev_b32 v8, 4, v11
    v_lshlrev_b32 v9, 5, v10
    v_sub_u32 v8, v8, v9
    v_add_u32 v8, 480, v8
    v_add_u32 v8, s70, v8
    v_and_b32 v4, 1, v11
    v_lshl_add_u32 v9, v4, 9, v9
    v_and_b32 v4, 2, v11
    v_lshl_add_u32 v9, v4, 3, v9
    s_lshl_b32 s3, s68, 12
    v_add_u32 v9, s3, v9
    v_lshrrev_b32 v4, 1, v10
    v_lshl_add_u32 v4, v11, 2, v4
    v_lshlrev_b32 v4, 2, v4
    v_and_b32 v10, 1, v10
    v_mul_u32_u24 v10, 4160, v10
    v_sub_u32 v4, v4, v10
    v_add_u32 v4, 4164, v4
    v_add_u32 v4, s69, v4
    v_add_u32 v5, 1024, v4
    v_add_u32 v6, 2048, v4
pad_ep_10:
    s_cbranch_execz pad_ep_11
    v_add_u32 v7, 3072, v4
    s_mov_b32 s78, 0
    s_add_u32 s3, s50, 161888
    v_mov_b32 v10, s3
    ds_read_b32 v10, v10
    s_waitcnt lgkmcnt(0)
    v_cmp_ne_u32 vcc, 0, v10
    s_nop 0
    s_cbranch_vccz conv
    s_waitcnt vmcnt(0)
    v_lshlrev_b32 v10, 13, v1
    v_mov_b32 v11, 1
    s_mov_b64 exec, 15
    buffer_store_dword v11, v10, s[60:63], s76 offen sc1
    s_mov_b64 exec, -1
    s_mov_b32 s78, 1
    s_cmp_ge_u32 s11, 25
    s_cbranch_scc1 atload
    s_add_u32 s3, s50, 161888
    v_mov_b32 v10, s3
spin_23:
    ds_read_b32 v11, v10
    s_waitcnt lgkmcnt(0)
    v_cmp_ne_u32 vcc, 0, v11
    s_nop 0
pad_ep_11:
    s_cbranch_execz pad_cv_0
    s_cbranch_vccz spin_23_ok
    s_sub_u32 s12, s12, 1
    s_cbranch_scc0 spin_23
    s_mov_b32 s12, 0
spin_23_ok:
conv:
pad_cv_0:
    s_cbranch_execz pad_cv_1
    v_add_u32 v8, s71, v8
    v_add_u32 v4, s71, v4
    v_add_u32 v5, s71, v5
    v_add_u32 v6, s71, v6
    v_add_u32 v7, s71, v7
    ds_read_b128 v[108:111], v8 offset:3584
    ds_read2_b32 v[44:45], v4 offset0:0 offset1:1
    ds_read2_b32 v[46:47], v4 offset0:2 offset1:3
    ds_read_b128 v[112:115], v8 offset:3072
    ds_read2_b32 v[48:49], v4 offset0:128 offset1:129
    ds_read2_b32 v[50:51], v4 offset0:130 offset1:131
    ds_read_b128 v[116:119], v8 offset:2560
    ds_read2_b32 v[52:53], v5 offset0:0 offset1:1
    ds_read2_b32 v[54:55], v5 offset0:2 offset1:3
    ds_read_b128 v[120:123], v8 offset:2048
    ds_read2_b32 v[56:57], v5 offset0:128 offset1:129
pad_cv_1:
    s_cbranch_execz pad_cv_2
    ds_read2_b32 v[58:59], v5 offset0:130 offset1:131
    ds_read_b128 v[124:127], v8 offset:1536
    ds_read2_b32 v[60:61], v6 offset0:0 offset1:1
    ds_read2_b32 v[62:63], v6 offset0:2 offset1:3
    ds_read_b128 v[128:131], v8 offset:1024
    ds_read2_b32 v[64:65], v6 offset0:128 offset1:129
    ds_read2_b32 v[66:67], v6 offset0:130 offset1:131
    ds_read_b128 v[132:135], v8 offset:512
    ds_read2_b32 v[68:69], v7 offset0:0 offset1:1
    ds_read2_b32 v[70:71], v7 offset0:2 offset1:3
    ds_read_b128 v[136:139], v8 offset:0
    ds_read2_b32 v[72:73], v7 offset0:128 offset1:129
    ds_read2_b32 v[74:75], v7 offset0:130 offset1:131
    v_mov_b64 v[12:13], 0
    v_mov_b64 v[14:15], 0
    v_mov_b64 v[16:17], 0
    v_mov_b64 v[18:19], 0
pad_cv_2:
    s_cbranch_execz pad_cv_3
    v_mov_b64 v[20:21], 0
    v_mov_b64 v[22:23], 0
    v_mov_b64 v[24:25], 0
    v_mov_b64 v[26:27], 0
    v_mov_b64 v[28:29], 0
    v_mov_b64 v[30:31], 0
    v_mov_b64 v[32:33], 0
    v_mov_b64 v[34:35], 0
    v_mov_b64 v[36:37], 0
    v_mov_b64 v[38:39], 0
    v_mov_b64 v[40:41], 0
    v_mov_b64 v[42:43], 0
cv_loop:
    s_waitcnt lgkmcnt(0)
    v_mfma_f32_16x16x32_bf16 v[12:15], v[44:47], v[108:111], v[12:15]
    ds_read_b128 v[140:143], v8 offset:3648
    v_mfma_f32_16x16x32_bf16 v[16:19], v[44:47], v[112:115], v[16:19]
    ds_read2_b32 v[76:77], v4 offset0:16 offset1:17
    v_mfma_f32_16x16x32_bf16 v[16:19], v[48:51], v[108:111], v[16:19]
    s_getreg_b32 s3, hwreg(HW_REG_IB_STS, 0, 4)
    s_or_b32 s3, s3, s78
    s_cbranch_scc0 hf_26
hf_26_b:
    ds_read2_b32 v[78:79], v4 offset0:18 offset1:19
    v_mfma_f32_16x16x32_bf16 v[20:23], v[44:47], v[116:119], v[20:23]
    ds_read_b128 v[144:147], v8 offset:3136
pad_cv_3:
    s_cbranch_execz lw_done
    v_mfma_f32_16x16x32_bf16 v[20:23], v[48:51], v[112:115], v[20:23]
    ds_read2_b32 v[80:81], v4 offset0:144 offset1:145
    v_mfma_f32_16x16x32_bf16 v[20:23], v[52:55], v[108:111], v[20:23]
    ds_read2_b32 v[82:83], v4 offset0:146 offset1:147
    v_mfma_f32_16x16x32_bf16 v[24:27], v[44:47], v[120:123], v[24:27]
    v_mfma_f32_16x16x32_bf16 v[24:27], v[48:51], v[116:119], v[24:27]
    ds_read_b128 v[148:151], v8 offset:2624
    v_mfma_f32_16x16x32_bf16 v[24:27], v[52:55], v[112:115], v[24:27]
    ds_read2_b32 v[84:85], v5 offset0:16 offset1:17
    v_mfma_f32_16x16x32_bf16 v[24:27], v[56:59], v[108:111], v[24:27]
    ds_read2_b32 v[86:87], v5 offset0:18 offset1:19
    v_mfma_f32_16x16x32_bf16 v[28:31], v[44:47], v[124:127], v[28:31]
    ds_read_b128 v[152:155], v8 offset:2112
    v_mfma_f32_16x16x32_bf16 v[28:31], v[48:51], v[120:123], v[28:31]
    ds_read2_b32 v[88:89], v5 offset0:144 offset1:145
walk_11:
pad_cv_4:
    s_cbranch_execz pad_cv_5
    v_mfma_f32_16x16x32_bf16 v[28:31], v[52:55], v[116:119], v[28:31]
    s_getreg_b32 s3, hwreg(HW_REG_IB_STS, 0, 4)
    s_or_b32 s3, s3, s78
    s_cbranch_scc0 hf_25
hf_25_b:
    ds_read2_b32 v[90:91], v5 offset0:146 offset1:147
    v_mfma_f32_16x16x32_bf16 v[28:31], v[56:59], v[112:115], v[28:31]
    v_mfma_f32_16x16x32_bf16 v[28:31], v[60:63], v[108:111], v[28:31]
    ds_read_b128 v[156:159], v8 offset:1600
    v_mfma_f32_16x16x32_bf16 v[32:35], v[44:47], v[128:131], v[32:35]
    ds_read2_b32 v[92:93], v6 offset0:16 offset1:17
    v_mfma_f32_16x16x32_bf16 v[32:35], v[48:51], v[124:127], v[32:35]
    ds_read2_b32 v[94:95], v6 offset0:18 offset1:19
    v_mfma_f32_16x16x32_bf16 v[32:35], v[52:55], v[120:123], v[32:35]
    ds_read_b128 v[160:163], v8 offset:1088
    v_mfma_f32_16x16x32_bf16 v[32:35], v[56:59], v[116:119], v[32:35]
    ds_read2_b32 v[96:97], v6 offset0:144 offset1:145
    v_mfma_f32_16x16x32_bf16 v[32:35], v[60:63], v[112:115], v[32:35]
pad_cv_5:
    s_cbranch_execz pad_cv_6
    ds_read2_b32 v[98:99], v6 offset0:146 offset1:147
    v_mfma_f32_16x16x32_bf16 v[32:35], v[64:67], v[108:111], v[32:35]
    v_mfma_f32_16x16x32_bf16 v[36:39], v[44:47], v[132:135], v[36:39]
    ds_read_b128 v[164:167], v8 offset:576
    v_mfma_f32_16x16x32_bf16 v[36:39], v[48:51], v[128:131], v[36:39]
    s_getreg_b32 s3, hwreg(HW_REG_IB_STS, 0, 4)
    s_or_b32 s3, s3, s78
    s_cbranch_scc0 hf_24
hf_24_b:
    ds_read2_b32 v[100:101], v7 offset0:16 offset1:17
    v_mfma_f32_16x16x32_bf16 v[36:39], v[52:55], v[124:127], v[36:39]
    ds_read2_b32 v[102:103], v7 offset0:18 offset1:19
    v_mfma_f32_16x16x32_bf16 v[36:39], v[56:59], v[120:123], v[36:39]
    ds_read_b128 v[168:171], v8 offset:64
    v_mfma_f32_16x16x32_bf16 v[36:39], v[60:63], v[116:119], v[36:39]
    ds_read2_b32 v[104:105], v7 offset0:144 offset1:145
    v_mfma_f32_16x16x32_bf16 v[36:39], v[64:67], v[112:115], v[36:39]
    ds_read2_b32 v[106:107], v7 offset0:146 offset1:147
pad_cv_6:
    s_cbranch_execz pad_cv_7
    v_mfma_f32_16x16x32_bf16 v[36:39], v[68:71], v[108:111], v[36:39]
    v_mfma_f32_16x16x32_bf16 v[40:43], v[44:47], v[136:139], v[40:43]
    v_mfma_f32_16x16x32_bf16 v[40:43], v[48:51], v[132:135], v[40:43]
    v_mfma_f32_16x16x32_bf16 v[40:43], v[52:55], v[128:131], v[40:43]
    v_mfma_f32_16x16x32_bf16 v[40:43], v[56:59], v[124:127], v[40:43]
    v_mfma_f32_16x16x32_bf16 v[40:43], v[60:63], v[120:123], v[40:43]
    v_mfma_f32_16x16x32_bf16 v[40:43], v[64:67], v[116:119], v[40:43]
    v_mfma_f32_16x16x32_bf16 v[40:43], v[68:71], v[112:115], v[40:43]
    v_mfma_f32_16x16x32_bf16 v[40:43], v[72:75], v[108:111], v[40:43]
    s_waitcnt lgkmcnt(0)
    v_mfma_f32_16x16x32_bf16 v[12:15], v[76:79], v[140:143], v[12:15]
    ds_read_b128 v[108:111], v8 offset:3712
    v_mfma_f32_16x16x32_bf16 v[16:19], v[76:79], v[144:147], v[16:19]
    ds_read2_b32 v[44:45], v4 offset0:32 offset1:33
    v_mfma_f32_16x16x32_bf16 v[16:19], v[80:83], v[140:143], v[16:19]
    s_getreg_b32 s3, hwreg(HW_REG_IB_STS, 0, 4)
    s_or_b32 s3, s3, s78
pad_cv_7:
    s_cbranch_execz pad_cv_8
    s_cbranch_scc0 hf_29
hf_29_b:
    ds_read2_b32 v[46:47], v4 offset0:34 offset1:35
    v_mfma_f32_16x16x32_bf16 v[20:23], v[76:79], v[148:151], v[20:23]
    ds_read_b128 v[112:115], v8 offset:3200
    v_mfma_f32_16x16x32_bf16 v[20:23], v[80:83], v[144:147], v[20:23]
    ds_read2_b32 v[48:49], v4 offset0:160 offset1:161
    v_mfma_f32_16x16x32_bf16 v[20:23], v[84:87], v[140:143], v[20:23]
    ds_read2_b32 v[50:51], v4 offset0:162 offset1:163
    v_mfma_f32_16x16x32_bf16 v[24:27], v[76:79], v[152:155], v[24:27]
    v_mfma_f32_16x16x32_bf16 v[24:27], v[80:83], v[148:151], v[24:27]
    ds_read_b128 v[116:119], v8 offset:2688
    v_mfma_f32_16x16x32_bf16 v[24:27], v[84:87], v[144:147], v[24:27]
    ds_read2_b32 v[52:53], v5 offset0:32 offset1:33
    v_mfma_f32_16x16x32_bf16 v[24:27], v[88:91], v[140:143], v[24:27]
    ds_read2_b32 v[54:55], v5 offset0:34 offset1:35
    v_mfma_f32_16x16x32_bf16 v[28:31], v[76:79], v[156:159], v[28:31]
pad_cv_8:
    s_cbranch_execz pad_cv_9
    ds_read_b128 v[120:123], v8 offset:2176
    v_mfma_f32_16x16x32_bf16 v[28:31], v[80:83], v[152:155], v[28:31]
    ds_read2_b32 v[56:57], v5 offset0:160 offset1:161
    v_mfma_f32_16x16x32_bf16 v[28:31], v[84:87], v[148:151], v[28:31]
    s_getreg_b32 s3, hwreg(HW_REG_IB_STS, 0, 4)
    s_or_b32 s3, s3, s78
    s_cbranch_scc0 hf_28
hf_28_b:
    ds_read2_b32 v[58:59], v5 offset0:162 offset1:163
    v_mfma_f32_16x16x32_bf16 v[28:31], v[88:91], v[144:147], v[28:31]
    v_mfma_f32_16x16x32_bf16 v[28:31], v[92:95], v[140:143], v[28:31]
    ds_read_b128 v[124:127], v8 offset:1664
    v_mfma_f32_16x16x32_bf16 v[32:35], v[76:79], v[160:163], v[32:35]
    ds_read2_b32 v[60:61], v6 offset0:32 offset1:33
    v_mfma_f32_16x16x32_bf16 v[32:35], v[80:83], v[156:159], v[32:35]
    ds_read2_b32 v[62:63], v6 offset0:34 offset1:35
    v_mfma_f32_16x16x32_bf16 v[32:35], v[84:87], v[152:155], v[32:35]
    ds_read_b128 v[128:131], v8 offset:1152
pad_cv_9:
    s_cbranch_execz pad_cv_10
    v_mfma_f32_16x16x32_bf16 v[32:35], v[88:91], v[148:151], v[32:35]
    ds_read2_b32 v[64:65], v6 offset0:160 offset1:161
    v_mfma_f32_16x16x32_bf16 v[32:35], v[92:95], v[144:147], v[32:35]
    ds_read2_b32 v[66:67], v6 offset0:162 offset1:163
    v_mfma_f32_16x16x32_bf16 v[32:35], v[96:99], v[140:143], v[32:35]
    v_mfma_f32_16x16x32_bf16 v[36:39], v[76:79], v[164:167], v[36:39]
    ds_read_b128 v[132:135], v8 offset:640
    v_mfma_f32_16x16x32_bf16 v[36:39], v[80:83], v[160:163], v[36:39]
    s_getreg_b32 s3, hwreg(HW_REG_IB_STS, 0, 4)
    s_or_b32 s3, s3, s78
    s_cbranch_scc0 hf_27
hf_27_b:
    ds_read2_b32 v[68:69], v7 offset0:32 offset1:33
    v_mfma_f32_16x16x32_bf16 v[36:39], v[84:87], v[156:159], v[36:39]
    ds_read2_b32 v[70:71], v7 offset0:34 offset1:35
    v_mfma_f32_16x16x32_bf16 v[36:39], v[88:91], v[152:155], v[36:39]
    ds_read_b128 v[136:139], v8 offset:128
    v_mfma_f32_16x16x32_bf16 v[36:39], v[92:95], v[148:151], v[36:39]
pad_cv_10:
    s_cbranch_execz pad_cv_11
    ds_read2_b32 v[72:73], v7 offset0:160 offset1:161
    v_mfma_f32_16x16x32_bf16 v[36:39], v[96:99], v[144:147], v[36:39]
    ds_read2_b32 v[74:75], v7 offset0:162 offset1:163
    v_mfma_f32_16x16x32_bf16 v[36:39], v[100:103], v[140:143], v[36:39]
    v_mfma_f32_16x16x32_bf16 v[40:43], v[76:79], v[168:171], v[40:43]
    v_add_u32 v8, 128, v8
    v_mfma_f32_16x16x32_bf16 v[40:43], v[80:83], v[164:167], v[40:43]
    v_add_u32 v4, 128, v4
    v_mfma_f32_16x16x32_bf16 v[40:43], v[84:87], v[160:163], v[40:43]
    v_add_u32 v5, 128, v5
    v_mfma_f32_16x16x32_bf16 v[40:43], v[88:91], v[156:159], v[40:43]
    v_add_u32 v6, 128, v6
    v_mfma_f32_16x16x32_bf16 v[40:43], v[92:95], v[152:155], v[40:43]
    v_add_u32 v7, 128, v7
    v_mfma_f32_16x16x32_bf16 v[40:43], v[96:99], v[148:151], v[40:43]
    s_sub_u32 s72, s72, 1
pad_cv_11:
    s_cbranch_execz pad_c2_0
    v_mfma_f32_16x16x32_bf16 v[40:43], v[100:103], v[144:147], v[40:43]
    s_cmp_lg_u32 s72, 0
    v_mfma_f32_16x16x32_bf16 v[40:43], v[104:107], v[140:143], v[40:43]
    s_cbranch_scc1 cv_loop
    s_waitcnt lgkmcnt(0)
    s_cmp_lg_u32 s78, 0
    s_cbranch_scc1 hf_done
    s_waitcnt vmcnt(0)
    v_lshlrev_b32 v10, 13, v1
    v_mov_b32 v11, 1
    s_mov_b64 exec, 15
    buffer_store_dword v11, v10, s[60:63], s76 offen sc1
    s_mov_b64 exec, -1
hf_done:
pad_c2_0:
    s_cbranch_execz pad_c2_1
    v_lshlrev_b32 v8, 4, v1
    v_add_u32 v8, s74, v8
    s_cmp_eq_u32 s73, 0
    s_cbranch_scc1 cv_store
    s_cmp_eq_u32 s73, 1
    s_cbranch_scc1 cv_a
    s_cmp_eq_u32 s15, 0
    s_cbranch_scc1 cv_mb
    s_and_b32 s3, s6, 3
    s_lshl2_add_u32 s3, s14, s3
    s_lshl_b32 s3, s3, 7
    s_add_u32 s3, s3, 0xa52800
    s_buffer_load_dwordx16 s[16:31], s[60:63], s3 glc
cv_mb:
pad_c2_1:
    s_cbranch_execz pad_c2_2
    ds_write_b128 v8, v[12:15] offset:0
    ds_write_b128 v8, v[16:19] offset:1024
    ds_write_b128 v8, v[20:23] offset:2048
    ds_write_b128 v8, v[24:27] offset:3072
    ds_write_b128 v8, v[28:31] offset:4096
    ds_write_b128 v8, v[32:35] offset:5120
    ds_write_b128 v8, v[36:39] offset:6144
    ds_write_b128 v8, v[40:43] offset:7168
    s_add_u32 s3, s50, 48
    v_mov_b32 v10, s3
    v_add_u32 v10, 163328, v10
    v_mov_b32 v11, 1
    ds_write_b32 v10, v11
    s_branch cv_next
cv_a:
    s_add_u32 s3, s50, 48
    v_mov_b32 v10, s3
    v_add_u32 v10, 163328, v10
spin_30:
    ds_read_b32 v11, v10
pad_c2_2:
    s_cbranch_execz pad_c2_3
    s_waitcnt lgkmcnt(0)
    v_cmp_eq_u32 vcc, 0, v11
    s_nop 0
    s_cbranch_vccz spin_30_ok
    s_sub_u32 s12, s12, 1
    s_cbranch_scc0 spin_30
    s_mov_b32 s12, 0
spin_30_ok:
    ds_read_b128 v[108:111], v8 offset:0
    ds_read_b128 v[112:115], v8 offset:1024
    ds_read_b128 v[116:119], v8 offset:2048
    ds_read_b128 v[120:123], v8 offset:3072
    ds_read_b128 v[124:127], v8 offset:4096
    ds_read_b128 v[128:131], v8 offset:5120
    ds_read_b128 v[132:135], v8 offset:6144
    ds_read_b128 v[136:139], v8 offset:7168
    s_add_u32 s3, s50, 96
    v_mov_b32 v10, s3
    v_add_u32 v10, 163328, v10
    v_mov_b32 v11, 1
    ds_write_b32 v10, v11
pad_c2_3:
    s_cbranch_execz pad_c2_4
    s_waitcnt lgkmcnt(8)
    v_add_f32 v12, v12, v108
    v_add_f32 v13, v13, v109
    v_add_f32 v14, v14, v110
    v_add_f32 v15, v15, v111
    s_waitcnt lgkmcnt(7)
    v_add_f32 v16, v16, v112
    v_add_f32 v17, v17, v113
    v_add_f32 v18, v18, v114
    v_add_f32 v19, v19, v115
    s_waitcnt lgkmcnt(6)
    v_add_f32 v20, v20, v116
    v_add_f32 v21, v21, v117
    v_add_f32 v22, v22, v118
    v_add_f32 v23, v23, v119
    s_waitcnt lgkmcnt(5)
    v_add_f32 v24, v24, v120
    v_add_f32 v25, v25, v121
    v_add_f32 v26, v26, v122
    v_add_f32 v27, v27, v123
    s_waitcnt lgkmcnt(4)
    v_add_f32 v28, v28, v124
    v_add_f32 v29, v29, v125
    v_add_f32 v30, v30, v126
    v_add_f32 v31, v31, v127
    s_waitcnt lgkmcnt(3)
    v_add_f32 v32, v32, v128
    v_add_f32 v33, v33, v129
    v_add_f32 v34, v34, v130
    v_add_f32 v35, v35, v131
    s_waitcnt lgkmcnt(2)
pad_c2_4:
    s_cbranch_execz pad_c2_5
    v_add_f32 v36, v36, v132
    v_add_f32 v37, v37, v133
    v_add_f32 v38, v38, v134
    v_add_f32 v39, v39, v135
    s_waitcnt lgkmcnt(1)
    v_add_f32 v40, v40, v136
    v_add_f32 v41, v41, v137
    v_add_f32 v42, v42, v138
    v_add_f32 v43, v43, v139
    s_cmp_eq_u32 s15, 0
    s_cbranch_scc1 cv_store
    s_and_b32 s3, s6, 3
    s_lshl2_add_u32 s3, s14, s3
    s_lshl_b32 s3, s3, 7
    s_add_u32 s3, s3, 0xa52800
    s_buffer_load_dwordx16 s[16:31], s[60:63], s3 glc
cv_store:
    s_mov_b32 s3, 0x700000
    v_cvt_pk_bf16_f32 v44, v12, v13
    v_cvt_pk_bf16_f32 v45, v14, v15
    v_cvt_pk_bf16_f32 v46, v16, v17
    v_cvt_pk_bf16_f32 v47, v18, v19
    v_cvt_pk_bf16_f32 v48, v20, v21
    v_cvt_pk_bf16_f32 v49, v22, v23
pad_c2_5:
    s_cbranch_execz pad_c2_6
    v_cvt_pk_bf16_f32 v50, v24, v25
    v_cvt_pk_bf16_f32 v51, v26, v27
    v_cvt_pk_bf16_f32 v52, v28, v29
    v_cvt_pk_bf16_f32 v53, v30, v31
    v_cvt_pk_bf16_f32 v54, v32, v33
    v_cvt_pk_bf16_f32 v55, v34, v35
    v_cvt_pk_bf16_f32 v56, v36, v37
    v_cvt_pk_bf16_f32 v57, v38, v39
    v_cvt_pk_bf16_f32 v58, v40, v41
    v_cvt_pk_bf16_f32 v59, v42, v43
    v_permlane16_swap_b32 v44, v46
    v_permlane16_swap_b32 v45, v47
    v_permlane16_swap_b32 v48, v50
    v_permlane16_swap_b32 v49, v51
    v_permlane16_swap_b32 v52, v54
    v_permlane16_swap_b32 v53, v55
    v_permlane16_swap_b32 v56, v58
    v_permlane16_swap_b32 v57, v59
    buffer_store_dwordx4 v[44:47], v9, s[60:63], s3 offen offset:0 sc1
pad_c2_6:
    s_cbranch_execz pad_c2_7
    buffer_store_dwordx4 v[48:51], v9, s[60:63], s3 offen offset:1024 sc1
    buffer_store_dwordx4 v[52:55], v9, s[60:63], s3 offen offset:2048 sc1
    buffer_store_dwordx4 v[56:59], v9, s[60:63], s3 offen offset:3072 sc1
    s_mov_b32 s100, 1
    s_cmp_ge_u32 s6, 4
    s_cbranch_scc1 g2pre
    s_lshl_b32 s3, s10, 7
    s_add_u32 s3, s3, 0xa53800
    v_mov_b32 v10, 0
    v_mov_b32 v11, 1
    s_waitcnt vmcnt(0)
    s_mov_b64 exec, 1
    buffer_atomic_add v11, v10, s[60:63], s3 offen sc0 sc1
    s_mov_b64 exec, -1
    s_lshl_b32 s3, s10, 12
    s_add_u32 s3, s3, 0xa48008
    v_lshlrev_b32 v8, 7, v1
    v_mov_b32 v9, 1
    s_waitcnt vmcnt(0)
    v_readfirstlane_b32 s4, v11
    s_nop 0
    s_cmp_lg_u32 s4, 79
    s_cbranch_scc1 cv_next
    s_mov_b32 exec_hi, 0
pad_c2_7:
    s_cbranch_execz lw_done
    buffer_store_dword v9, v8, s[60:63], s3 offen sc1
    s_mov_b32 exec_hi, -1
cv_next:
    s_cmp_ge_u32 s6, 4
    s_cbranch_scc1 g2pre
atload:
pad_at_0:
    s_cbranch_execz pad_at_1
    v_lshlrev_b32 v2, 4, v1
    s_mul_i32 s3, s6, 20480
    v_add_u32 v3, s3, v2
    s_add_u32 s3, s6, 1
    s_and_b32 s3, s3, 3
    s_lshl_b32 s36, s3, 10
    s_add_u32 s3, s6, 2
    s_and_b32 s3, s3, 3
    s_lshl_b32 s37, s3, 10
    s_add_u32 s3, s6, 3
    s_and_b32 s3, s3, 3
    s_lshl_b32 s38, s3, 10
    s_add_u32 s3, s6, 4
    s_and_b32 s3, s3, 3
    s_lshl_b32 s39, s3, 10
    s_add_u32 s4, s6, 3
    s_and_b32 s4, s4, 3
    s_mul_i32 s4, s4, 20480
    v_add_u32 v212, s4, v2
    s_add_u32 s4, s6, 2
    s_and_b32 s4, s4, 3
    s_mul_i32 s4, s4, 20480
pad_at_1:
    s_cbranch_execz pad_at_2
    v_add_u32 v213, s4, v2
    s_add_u32 s4, s6, 1
    s_and_b32 s4, s4, 3
    s_mul_i32 s4, s4, 20480
    v_add_u32 v214, s4, v2
    v_lshrrev_b32 v221, 4, v1
    v_bfe_u32 v217, v1, 2, 2
    v_lshl_add_u32 v217, v221, 2, v217
    v_mul_u32_u24 v217, 144, v217
    v_and_b32 v220, 3, v1
    v_lshl_add_u32 v217, v220, 3, v217
    s_lshr_b32 s4, s39, 5
    s_add_u32 s4, s4, s75
    v_add_u32 v217, s4, v217
    v_mul_u32_u24 v215, 576, v221
    v_add_u32 v215, v215, v217
    v_and_b32 v220, 15, v1
    s_lshr_b32 s4, s39, 6
    v_add_u32 v220, s4, v220
    s_add_u32 s4, s75, 11520
    v_lshl_add_u32 v218, v220, 2, s4
    v_mul_u32_u24 v224, 1280, v220
pad_at_2:
    s_cbranch_execz pad_at_3
    v_lshl_add_u32 v224, v221, 3, v224
    s_mul_i32 s4, s13, 81920
    v_add_u32 v224, s4, v224
    s_mul_i32 s4, s14, 160
    v_add_u32 v224, s4, v224
    v_lshl_add_u32 v216, v221, 3, v224
    s_lshl_b32 s3, s6, 6
    v_add_u32 v4, s3, v1
    v_lshrrev_b32 v5, 3, v4
    v_and_b32 v4, 7, v4
    v_lshlrev_b32 v4, 4, v4
    v_mul_u32_u24 v7, 144, v5
    v_add3_u32 v7, v7, v4, s75
    v_lshl_add_u32 v4, v5, 12, v4
pw_31:
    s_buffer_load_dwordx4 s[32:35], s[60:63], s51 glc
    s_waitcnt lgkmcnt(0)
    s_cmp_eq_u32 s34, 1
    s_cbranch_scc1 pw_31_ok
    s_sleep 2
    s_sub_u32 s12, s12, 1
    s_cbranch_scc0 pw_31
    s_mov_b32 s12, 0
pw_31_ok:
    s_cmp_lg_u32 s6, 3
pad_at_3:
    s_cbranch_execz lw_done
    s_cbranch_scc1 at_ge
    s_mul_i32 s3, s13, 2560
    s_add_u32 s3, s3, 0xa00000
    v_lshlrev_b32 v5, 2, v1
    buffer_load_dword v16, v5, s[60:63], s3 offen offset:0 sc1
    buffer_load_dword v17, v5, s[60:63], s3 offen offset:256 sc1
    buffer_load_dword v18, v5, s[60:63], s3 offen offset:512 sc1
    buffer_load_dword v19, v5, s[60:63], s3 offen offset:768 sc1
    buffer_load_dword v20, v5, s[60:63], s3 offen offset:1024 sc1
    buffer_load_dword v21, v5, s[60:63], s3 offen offset:1280 sc1
    buffer_load_dword v22, v5, s[60:63], s3 offen offset:1536 sc1
    buffer_load_dword v23, v5, s[60:63], s3 offen offset:1792 sc1
    buffer_load_dword v24, v5, s[60:63], s3 offen offset:2048 sc1
    buffer_load_dword v25, v5, s[60:63], s3 offen offset:2304 sc1
at_ge:
    v_and_b32 v254, 3, v1
    v_lshlrev_b32 v254, 2, v254
    v_add_u32 v254, 163328, v254
spin_32:
    ds_read_b32 v255, v254
walk_13:
pad_at_4:
    s_cbranch_execz pad_at_5
    s_waitcnt lgkmcnt(0)
    v_cmp_eq_u32 vcc, 0, v255
    s_nop 0
    s_cbranch_vccz spin_32_ok
    s_sleep 2
    s_sub_u32 s12, s12, 1
    s_cbranch_scc0 spin_32
    s_mov_b32 s12, 0
spin_32_ok:
    s_mul_i32 s4, s14, 327680
    s_lshl_b32 s3, s13, 7
    s_add_u32 s4, s4, s3
    s_add_u32 s4, s4, 0x700000
    buffer_load_dwordx4 v[8:11], v4, s[60:63], s4 offen sc1
    s_add_u32 s4, s4, 131072
    buffer_load_dwordx4 v[12:15], v4, s[60:63], s4 offen sc1
    s_add_u32 s4, s4, 131072
    s_cmp_ge_u32 s6, 2
    s_cbranch_scc1 at_g
    buffer_load_dwordx4 v[16:19], v4, s[60:63], s4 offen sc1
    s_branch at_w
at_g:
    s_cmp_eq_u32 s6, 2
    s_cbranch_scc1 at_w
    s_waitcnt vmcnt(2)
pad_at_5:
    s_cbranch_execz pad_at_6
    v_add_f32 v16, v16, v18
    v_add_f32 v17, v17, v19
    v_add_f32 v20, v20, v22
    v_add_f32 v21, v21, v23
    v_add_f32 v16, v16, v24
    v_add_f32 v17, v17, v25
    v_add_f32 v16, v16, v20
    v_add_f32 v17, v17, v21
    s_add_u32 s3, s75, 11520
    v_add_u32 v5, s3, v5
    v_add_f32 v16, v16, v17
    v_mul_f32 v16, 0xbfb8aa3b, v16
    v_exp_f32 v16, v16
    s_nop 0
    v_add_f32 v16, 1.0, v16
    v_rcp_f32 v16, v16
    s_nop 0
at_w:
    s_cmp_eq_u32 s15, 0
    s_cbranch_scc1 at_free
    v_and_b32 v254, 1, v1
    v_lshlrev_b32 v254, 2, v254
    v_add_u32 v254, 163440, v254
spin_33:
    ds_read_b32 v255, v254
    s_waitcnt lgkmcnt(0)
    v_cmp_eq_u32 vcc, 0, v255
    s_nop 0
    s_cbranch_vccz spin_33_ok
pad_at_6:
    s_cbranch_execz pad_at_7
    s_sleep 2
    s_sub_u32 s12, s12, 1
    s_cbranch_scc0 spin_33
    s_mov_b32 s12, 0
spin_33_ok:
at_free:
    s_waitcnt vmcnt(0)
    ds_write_b128 v7, v[8:11]
    ds_write_b128 v7, v[12:15] offset:4608
    s_cmp_ge_u32 s6, 2
    s_cbranch_scc1 at_gw
    ds_write_b128 v7, v[16:19] offset:9216
    s_branch final
at_gw:
    s_cmp_eq_u32 s6, 2
    s_cbranch_scc1 final
    ds_write_b32 v5, v16
    s_branch final
hf_24:
    s_waitcnt vmcnt(0)
    v_lshlrev_b32 v10, 13, v1
    v_mov_b32 v11, 1
    s_mov_b64 exec, 15
    buffer_store_dword v11, v10, s[60:63], s76 offen sc1
    s_mov_b64 exec, -1
    s_mov_b32 s78, 1
    s_branch hf_24_b
hf_25:
    s_waitcnt vmcnt(0)
    v_lshlrev_b32 v10, 13, v1
    v_mov_b32 v11, 1
pad_at_7:
    s_cbranch_execz pad_at_8
    s_mov_b64 exec, 15
    buffer_store_dword v11, v10, s[60:63], s76 offen sc1
    s_mov_b64 exec, -1
    s_mov_b32 s78, 1
    s_branch hf_25_b
hf_26:
    s_waitcnt vmcnt(0)
    v_lshlrev_b32 v10, 13, v1
    v_mov_b32 v11, 1
    s_mov_b64 exec, 15
    buffer_store_dword v11, v10, s[60:63], s76 offen sc1
    s_mov_b64 exec, -1
    s_mov_b32 s78, 1
    s_branch hf_26_b
hf_27:
    s_waitcnt vmcnt(0)
    v_lshlrev_b32 v10, 13, v1
    v_mov_b32 v11, 1
    s_mov_b64 exec, 15
    buffer_store_dword v11, v10, s[60:63], s76 offen sc1
    s_mov_b64 exec, -1
    s_mov_b32 s78, 1
    s_branch hf_27_b
hf_28:
    s_waitcnt vmcnt(0)
    v_lshlrev_b32 v10, 13, v1
    v_mov_b32 v11, 1
    s_mov_b64 exec, 15
    buffer_store_dword v11, v10, s[60:63], s76 offen sc1
    s_mov_b64 exec, -1
pad_at_8:
    s_cbranch_execz pad_fin_0
    s_mov_b32 s78, 1
    s_branch hf_28_b
hf_29:
    s_waitcnt vmcnt(0)
    v_lshlrev_b32 v10, 13, v1
    v_mov_b32 v11, 1
    s_mov_b64 exec, 15
    buffer_store_dword v11, v10, s[60:63], s76 offen sc1
    s_mov_b64 exec, -1
    s_mov_b32 s78, 1
    s_branch hf_29_b
lw_go:
    s_mov_b64 exec, 0
lw_done:
    s_ff1_i32_b32 s3, s101
    s_bitset0_b32 s101, s3
    s_cmp_eq_u32 s3, 0
    s_cbranch_scc1 walk_10
    s_cmp_eq_u32 s3, 1
    s_cbranch_scc1 walk_11
    s_cmp_eq_u32 s3, 2
    s_cbranch_scc1 walk_12
    s_cmp_eq_u32 s3, 3
    s_cbranch_scc1 walk_13
    s_cmp_eq_u32 s3, 4
    s_cbranch_scc1 walk_14
    s_cmp_eq_u32 s3, 5
    s_cbranch_scc1 walk_15
    s_cmp_eq_u32 s3, 6
    s_cbranch_scc1 walk_16
    s_cmp_eq_u32 s3, 7
    s_cbranch_scc1 walk_17
    s_mov_b64 exec, -1
    s_cmp_lg_u32 s15, 0
    s_cbranch_scc1 lw_sback
    s_branch lw_gback
g2pre:
walk_12:
pad_g2p_0:
    s_cbranch_execz pad_g2p_1
    s_and_b32 s5, s6, 3
    s_lshr_b32 s3, s5, 1
    s_sub_u32 s68, 14, s3
    s_mul_i32 s76, s5, 14
    s_cmp_eq_u32 s5, 3
    s_subb_u32 s76, s76, 0
    s_and_b32 s3, s13, 7
    s_mul_i32 s3, s3, 0
    s_lshr_b32 s3, s3, 3
    s_and_b32 s4, s14, 3
    s_mul_i32 s4, s4, 0
    s_lshr_b32 s4, s4, 1
    s_add_u32 s3, s3, s4
    s_sub_u32 s4, s3, s68
    s_cselect_b32 s3, s3, s4
    s_mul_i32 s4, s14, 54
    s_add_u32 s4, s4, s76
    s_mul_i32 s4, s4, 5120
    s_add_u32 s69, s4, 0x1000000
    s_mul_i32 s4, s68, 5120
    s_add_u32 s70, s69, s4
    s_mul_i32 s4, s3, 5120
    s_add_u32 s71, s69, s4
    s_mul_i32 s4, s13, 54
pad_g2p_1:
    s_cbranch_execz pad_g2p_2
    s_add_u32 s4, s4, s76
    s_lshl_b32 s72, s4, 12
    s_lshl_b32 s4, s68, 12
    s_add_u32 s73, s72, s4
    s_lshl_b32 s4, s3, 12
    s_add_u32 s74, s72, s4
    v_lshlrev_b32 v2, 4, v1
    s_mul_i32 s77, s5, 20480
    v_add_u32 v3, s77, v2
fw_34:
    s_waitcnt lgkmcnt(0)
    s_bitcmp1_b32 s6, 1
    s_cselect_b32 s29, 1, s29
    s_and_b64 s[16:17], s[16:17], s[18:19]
    s_and_b64 s[16:17], s[16:17], s[20:21]
    s_and_b64 s[16:17], s[16:17], s[22:23]
    s_and_b64 s[16:17], s[16:17], s[24:25]
    s_and_b64 s[16:17], s[16:17], s[26:27]
    s_and_b64 s[16:17], s[16:17], s[28:29]
    s_and_b32 s16, s16, s17
    s_cmp_eq_u32 s16, 1
    s_cbranch_scc1 fw_34_ok
    s_sleep 2
    s_and_b32 s3, s6, 3
    s_lshl2_add_u32 s3, s14, s3
    s_lshl_b32 s3, s3, 7
    s_add_u32 s3, s3, 0xa52800
    s_buffer_load_dwordx16 s[16:31], s[60:63], s3 glc
    s_sub_u32 s12, s12, 1
pad_g2p_2:
    s_cbranch_execz pad_g2p_3
    s_cbranch_scc0 fw_34
    s_mov_b32 s12, 0
    s_waitcnt lgkmcnt(0)
fw_34_ok:
    s_add_u32 s3, s71, 4096
    buffer_load_dwordx4 v[132:135], v2, s[60:63], s71 offen offset:0 sc1
    buffer_load_dwordx4 v[136:139], v2, s[60:63], s71 offen offset:1024 sc1
    buffer_load_dwordx4 v[140:143], v2, s[60:63], s71 offen offset:2048 sc1
    buffer_load_dwordx4 v[144:147], v2, s[60:63], s71 offen offset:3072 sc1
    buffer_load_dwordx4 v[148:151], v2, s[60:63], s3 offen offset:0 sc1
    s_add_u32 s71, s71, 5120
    s_cmp_eq_u32 s71, s70
    s_cselect_b32 s71, s69, s71
    s_add_u32 s3, s71, 4096
    buffer_load_dwordx4 v[152:155], v2, s[60:63], s71 offen offset:0 sc1
    buffer_load_dwordx4 v[156:159], v2, s[60:63], s71 offen offset:1024 sc1
    buffer_load_dwordx4 v[160:163], v2, s[60:63], s71 offen offset:2048 sc1
    buffer_load_dwordx4 v[164:167], v2, s[60:63], s71 offen offset:3072 sc1
    buffer_load_dwordx4 v[168:171], v2, s[60:63], s3 offen offset:0 sc1
pad_g2p_3:
    s_cbranch_execz pad_g2p_4
    s_add_u32 s71, s71, 5120
    s_cmp_eq_u32 s71, s70
    s_cselect_b32 s71, s69, s71
    s_cmp_lg_u32 s15, 0
    s_cbranch_scc1 g2_free
g2_hw:
    v_mov_b32 v216, 0
    v_mov_b32 v224, 0
    s_and_b32 s3, s6, 3
    s_lshl_b32 s3, s3, 3
    s_lshr_b32 s3, 0x88442211, s3
    s_and_b32 s101, s3, 255
    s_branch lw_go
lw_gback:
    v_and_b32 v254, 3, v1
    v_lshlrev_b32 v254, 2, v254
    v_add_u32 v254, 161856, v254
spin_35:
    ds_read_b32 v255, v254
    s_waitcnt lgkmcnt(0)
    v_cmp_ne_u32 vcc, 0, v255
    s_nop 0
    s_cbranch_vccz spin_35_ok
    s_sleep 1
    s_sub_u32 s12, s12, 1
    s_cbranch_scc0 spin_35
    s_mov_b32 s12, 0
spin_35_ok:
g2_free:
    s_add_u32 s3, s71, 4096
pad_g2p_4:
    s_cbranch_execz pad_g2p_5
    buffer_load_dwordx4 v[172:175], v2, s[60:63], s71 offen offset:0 sc1
    buffer_load_dwordx4 v[176:179], v2, s[60:63], s71 offen offset:1024 sc1
    buffer_load_dwordx4 v[180:183], v2, s[60:63], s71 offen offset:2048 sc1
    buffer_load_dwordx4 v[184:187], v2, s[60:63], s71 offen offset:3072 sc1
    buffer_load_dwordx4 v[188:191], v2, s[60:63], s3 offen offset:0 sc1
    s_add_u32 s71, s71, 5120
    s_cmp_eq_u32 s71, s70
    s_cselect_b32 s71, s69, s71
    s_add_u32 s3, s71, 4096
    buffer_load_dwordx4 v[192:195], v2, s[60:63], s71 offen offset:0 sc1
    buffer_load_dwordx4 v[196:199], v2, s[60:63], s71 offen offset:1024 sc1
    buffer_load_dwordx4 v[200:203], v2, s[60:63], s71 offen offset:2048 sc1
    buffer_load_dwordx4 v[204:207], v2, s[60:63], s71 offen offset:3072 sc1
    buffer_load_dwordx4 v[208:211], v2, s[60:63], s3 offen offset:0 sc1
    s_add_u32 s71, s71, 5120
    s_cmp_eq_u32 s71, s70
    s_cselect_b32 s71, s69, s71
    s_add_u32 s3, s71, 4096
pad_g2p_5:
    s_cbranch_execz pad_g2p_6
    buffer_load_dwordx4 v[212:215], v2, s[60:63], s71 offen offset:0 sc1
    buffer_load_dwordx4 v[216:219], v2, s[60:63], s71 offen offset:1024 sc1
    buffer_load_dwordx4 v[220:223], v2, s[60:63], s71 offen offset:2048 sc1
    buffer_load_dwordx4 v[224:227], v2, s[60:63], s71 offen offset:3072 sc1
    buffer_load_dwordx4 v[228:231], v2, s[60:63], s3 offen offset:0 sc1
    s_add_u32 s71, s71, 5120
    s_cmp_eq_u32 s71, s70
    s_cselect_b32 s71, s69, s71
    s_add_u32 s3, s71, 4096
    buffer_load_dwordx4 v[232:235], v2, s[60:63], s71 offen offset:0 sc1
    buffer_load_dwordx4 v[236:239], v2, s[60:63], s71 offen offset:1024 sc1
    buffer_load_dwordx4 v[240:243], v2, s[60:63], s71 offen offset:2048 sc1
    buffer_load_dwordx4 v[244:247], v2, s[60:63], s71 offen offset:3072 sc1
    buffer_load_dwordx4 v[248:251], v2, s[60:63], s3 offen offset:0 sc1
    s_add_u32 s71, s71, 5120
    s_cmp_eq_u32 s71, s70
    s_cselect_b32 s71, s69, s71
pad_g2p_6:
    s_cbranch_execz pad_g2p_7
    s_cmp_eq_u32 s100, 0
    s_cbranch_scc1 g2_nc
    s_lshl_b32 s3, s10, 7
    s_add_u32 s3, s3, 0xa53800
    v_mov_b32 v252, 0
    v_mov_b32 v253, 1
    s_waitcnt vmcnt(30)
    s_mov_b64 exec, 1
    buffer_atomic_add v253, v252, s[60:63], s3 offen sc0 sc1
    s_mov_b64 exec, -1
g2_nc:
    s_lshr_b32 s3, s13, 1
    s_and_b32 s4, s6, 3
    s_lshl2_add_u32 s3, s3, s4
    s_lshl_b32 s3, s3, 7
    s_and_b32 s4, s14, 3
    s_lshl_b32 s4, s4, 13
    s_add_u32 s3, s3, s4
    s_add_u32 s79, s3, 0xa40000
g2_dma:
    s_mov_b32 m0, s77
    s_mov_b32 s78, 4
g2_dma_l:
    s_cmp_gt_u32 s78, 1
    s_cbranch_scc1 g2_nos
    s_buffer_load_dwordx16 s[16:31], s[60:63], s79 glc
g2_nos:
    s_add_u32 s3, s71, 1024
    buffer_load_dwordx4 v2, s[60:63], s71 offen sc1 lds
pad_g2p_7:
    s_cbranch_execz pad_g2p_8
    s_add_u32 m0, m0, 1024
    s_add_u32 s71, s71, 5120
    s_cmp_eq_u32 s71, s70
    s_cselect_b32 s71, s69, s71
    buffer_load_dwordx4 v2, s[60:63], s3 offen offset:0 sc1 lds
    buffer_load_dwordx4 v2, s[60:63], s3 offen offset:1024 sc1 lds
    buffer_load_dwordx4 v2, s[60:63], s3 offen offset:2048 sc1 lds
    buffer_load_dwordx4 v2, s[60:63], s3 offen offset:3072 sc1 lds
    s_add_u32 m0, m0, 4096
    s_sub_u32 s78, s78, 1
    s_cmp_lg_u32 s78, 0
    s_cbranch_scc1 g2_dma_l
    s_mov_b32 s64, s44
    s_mov_b32 s65, s45
    s_mov_b32 s66, 0x280000
    s_mov_b32 s67, 0x20000
    s_add_u32 s3, s6, 1
    s_and_b32 s3, s3, 3
    s_lshl_b32 s36, s3, 10
    s_add_u32 s3, s6, 2
    s_and_b32 s3, s3, 3
    s_lshl_b32 s37, s3, 10
pad_g2p_8:
    s_cbranch_execz pad_g2p_9
    s_add_u32 s3, s6, 3
    s_and_b32 s3, s3, 3
    s_lshl_b32 s38, s3, 10
    s_add_u32 s3, s6, 4
    s_and_b32 s3, s3, 3
    s_lshl_b32 s39, s3, 10
    s_cmp_eq_u32 s100, 0
    s_cbranch_scc1 g2_nr
    s_waitcnt vmcnt(20)
    v_readfirstlane_b32 s4, v253
    s_nop 0
    s_cmp_lg_u32 s4, 79
    s_cbranch_scc1 g2_nr
    s_lshl_b32 s3, s10, 12
    s_add_u32 s3, s3, 0xa48008
    v_lshlrev_b32 v252, 7, v1
    v_mov_b32 v253, 1
    s_mov_b32 exec_hi, 0
    buffer_store_dword v253, v252, s[60:63], s3 offen sc1
    s_mov_b32 exec_hi, -1
g2_nr:
fw_36:
    s_waitcnt lgkmcnt(0)
    s_bitcmp1_b32 s6, 1
    s_cselect_b32 s29, 1, s29
    s_and_b64 s[16:17], s[16:17], s[18:19]
    s_and_b64 s[16:17], s[16:17], s[20:21]
    s_and_b64 s[16:17], s[16:17], s[22:23]
    s_and_b64 s[16:17], s[16:17], s[24:25]
    s_and_b64 s[16:17], s[16:17], s[26:27]
pad_g2p_9:
    s_cbranch_execz pad_at_0
    s_and_b64 s[16:17], s[16:17], s[28:29]
    s_and_b32 s16, s16, s17
    s_cmp_eq_u32 s16, 1
    s_cbranch_scc1 fw_36_ok
    s_sleep 1
    s_buffer_load_dwordx16 s[16:31], s[60:63], s79 glc
    s_sub_u32 s12, s12, 1
    s_cbranch_scc0 fw_36
    s_mov_b32 s12, 0
    s_waitcnt lgkmcnt(0)
fw_36_ok:
walk_14:
pad_g2_0:
    s_cbranch_execz pad_g2_1
    s_add_u32 s5, s74, s36
    buffer_load_dwordx4 v[84:87], v2, s[60:63], s5 offen sc1
    s_add_u32 s5, s74, s37
    buffer_load_dwordx4 v[88:91], v2, s[60:63], s5 offen sc1
    s_add_u32 s5, s74, s38
    buffer_load_dwordx4 v[92:95], v2, s[60:63], s5 offen sc1
    s_add_u32 s5, s74, s39
    buffer_load_dwordx4 v[96:99], v2, s[60:63], s5 offen sc1
    s_add_u32 s74, s74, 4096
    s_cmp_eq_u32 s74, s73
    s_cselect_b32 s74, s72, s74
    s_add_u32 s5, s74, s36
    buffer_load_dwordx4 v[100:103], v2, s[60:63], s5 offen sc1
pad_g2_1:
    s_cbranch_execz pad_g2_2
    s_add_u32 s5, s74, s37
    buffer_load_dwordx4 v[104:107], v2, s[60:63], s5 offen sc1
    s_add_u32 s5, s74, s38
    buffer_load_dwordx4 v[108:111], v2, s[60:63], s5 offen sc1
    s_add_u32 s5, s74, s39
    buffer_load_dwordx4 v[112:115], v2, s[60:63], s5 offen sc1
    s_add_u32 s74, s74, 4096
    s_cmp_eq_u32 s74, s73
    s_cselect_b32 s74, s72, s74
    s_add_u32 s5, s74, s36
    buffer_load_dwordx4 v[116:119], v2, s[60:63], s5 offen sc1
    s_add_u32 s5, s74, s37
    buffer_load_dwordx4 v[120:123], v2, s[60:63], s5 offen sc1
    s_add_u32 s5, s74, s38
    buffer_load_dwordx4 v[124:127], v2, s[60:63], s5 offen sc1
    s_add_u32 s5, s74, s39
    buffer_load_dwordx4 v[128:131], v2, s[60:63], s5 offen sc1
    s_add_u32 s74, s74, 4096
    s_cmp_eq_u32 s74, s73
    s_cselect_b32 s74, s72, s74
    s_waitcnt vmcnt(11)
    v_mfma_f32_16x16x32_bf16 v[4:7], v[132:135], v[84:87], 0
pad_g2_2:
    s_cbranch_execz pad_g2_3
    v_mfma_f32_16x16x32_bf16 v[8:11], v[136:139], v[84:87], 0
    v_mfma_f32_16x16x32_bf16 v[12:15], v[140:143], v[84:87], 0
    v_mfma_f32_16x16x32_bf16 v[16:19], v[144:147], v[84:87], 0
    v_mfma_f32_16x16x32_bf16 v[20:23], v[148:151], v[84:87], 0
    s_add_u32 s5, s74, s36
    buffer_load_dwordx4 v[84:87], v2, s[60:63], s5 offen sc1
    s_waitcnt vmcnt(11)
    v_mfma_f32_16x16x32_bf16 v[24:27], v[132:135], v[88:91], 0
    v_mfma_f32_16x16x32_bf16 v[28:31], v[136:139], v[88:91], 0
    v_mfma_f32_16x16x32_bf16 v[32:35], v[140:143], v[88:91], 0
    v_mfma_f32_16x16x32_bf16 v[36:39], v[144:147], v[88:91], 0
    v_mfma_f32_16x16x32_bf16 v[40:43], v[148:151], v[88:91], 0
    s_add_u32 s5, s74, s37
    buffer_load_dwordx4 v[88:91], v2, s[60:63], s5 offen sc1
    s_waitcnt vmcnt(11)
    v_mfma_f32_16x16x32_bf16 v[44:47], v[132:135], v[92:95], 0
    v_mfma_f32_16x16x32_bf16 v[48:51], v[136:139], v[92:95], 0
pad_g2_3:
    s_cbranch_execz pad_g2_4
    v_mfma_f32_16x16x32_bf16 v[52:55], v[140:143], v[92:95], 0
    v_mfma_f32_16x16x32_bf16 v[56:59], v[144:147], v[92:95], 0
    v_mfma_f32_16x16x32_bf16 v[60:63], v[148:151], v[92:95], 0
    s_add_u32 s5, s74, s38
    buffer_load_dwordx4 v[92:95], v2, s[60:63], s5 offen sc1
    s_waitcnt vmcnt(11)
    v_mfma_f32_16x16x32_bf16 v[64:67], v[132:135], v[96:99], 0
    v_mfma_f32_16x16x32_bf16 v[68:71], v[136:139], v[96:99], 0
    v_mfma_f32_16x16x32_bf16 v[72:75], v[140:143], v[96:99], 0
    v_mfma_f32_16x16x32_bf16 v[76:79], v[144:147], v[96:99], 0
    v_mfma_f32_16x16x32_bf16 v[80:83], v[148:151], v[96:99], 0
    s_add_u32 s5, s74, s39
    buffer_load_dwordx4 v[96:99], v2, s[60:63], s5 offen sc1
    s_add_u32 s74, s74, 4096
    s_cmp_eq_u32 s74, s73
    s_cselect_b32 s74, s72, s74
    s_waitcnt vmcnt(11)
    v_mfma_f32_16x16x32_bf16 v[4:7], v[152:155], v[100:103], v[4:7]
    s_add_u32 s3, s71, 4096
pad_g2_4:
    s_cbranch_execz pad_g2_5
    buffer_load_dwordx4 v[132:135], v2, s[60:63], s71 offen offset:0 sc1
    v_mfma_f32_16x16x32_bf16 v[8:11], v[156:159], v[100:103], v[8:11]
    buffer_load_dwordx4 v[136:139], v2, s[60:63], s71 offen offset:1024 sc1
    v_mfma_f32_16x16x32_bf16 v[12:15], v[160:163], v[100:103], v[12:15]
    v_mfma_f32_16x16x32_bf16 v[16:19], v[164:167], v[100:103], v[16:19]
    v_mfma_f32_16x16x32_bf16 v[20:23], v[168:171], v[100:103], v[20:23]
    s_add_u32 s5, s74, s36
    buffer_load_dwordx4 v[100:103], v2, s[60:63], s5 offen sc1
    s_waitcnt vmcnt(13)
    v_mfma_f32_16x16x32_bf16 v[24:27], v[152:155], v[104:107], v[24:27]
    v_mfma_f32_16x16x32_bf16 v[28:31], v[156:159], v[104:107], v[28:31]
    v_mfma_f32_16x16x32_bf16 v[32:35], v[160:163], v[104:107], v[32:35]
    v_mfma_f32_16x16x32_bf16 v[36:39], v[164:167], v[104:107], v[36:39]
    v_mfma_f32_16x16x32_bf16 v[40:43], v[168:171], v[104:107], v[40:43]
    s_add_u32 s5, s74, s37
    buffer_load_dwordx4 v[104:107], v2, s[60:63], s5 offen sc1
    s_waitcnt vmcnt(13)
pad_g2_5:
    s_cbranch_execz pad_g2_6
    v_mfma_f32_16x16x32_bf16 v[44:47], v[152:155], v[108:111], v[44:47]
    v_mfma_f32_16x16x32_bf16 v[48:51], v[156:159], v[108:111], v[48:51]
    v_mfma_f32_16x16x32_bf16 v[52:55], v[160:163], v[108:111], v[52:55]
    v_mfma_f32_16x16x32_bf16 v[56:59], v[164:167], v[108:111], v[56:59]
    v_mfma_f32_16x16x32_bf16 v[60:63], v[168:171], v[108:111], v[60:63]
    s_add_u32 s5, s74, s38
    buffer_load_dwordx4 v[108:111], v2, s[60:63], s5 offen sc1
    s_waitcnt vmcnt(13)
    v_mfma_f32_16x16x32_bf16 v[64:67], v[152:155], v[112:115], v[64:67]
    v_mfma_f32_16x16x32_bf16 v[68:71], v[156:159], v[112:115], v[68:71]
    v_mfma_f32_16x16x32_bf16 v[72:75], v[160:163], v[112:115], v[72:75]
    v_mfma_f32_16x16x32_bf16 v[76:79], v[164:167], v[112:115], v[76:79]
    v_mfma_f32_16x16x32_bf16 v[80:83], v[168:171], v[112:115], v[80:83]
    s_add_u32 s5, s74, s39
    buffer_load_dwordx4 v[112:115], v2, s[60:63], s5 offen sc1
    s_add_u32 s74, s74, 4096
    s_cmp_eq_u32 s74, s73
    s_cselect_b32 s74, s72, s74
pad_g2_6:
    s_cbranch_execz pad_g2_7
    s_waitcnt vmcnt(13)
    v_mfma_f32_16x16x32_bf16 v[4:7], v[172:175], v[116:119], v[4:7]
    buffer_load_dwordx4 v[140:143], v2, s[60:63], s71 offen offset:2048 sc1
    v_mfma_f32_16x16x32_bf16 v[8:11], v[176:179], v[116:119], v[8:11]
    buffer_load_dwordx4 v[144:147], v2, s[60:63], s71 offen offset:3072 sc1
    v_mfma_f32_16x16x32_bf16 v[12:15], v[180:183], v[116:119], v[12:15]
    v_mfma_f32_16x16x32_bf16 v[16:19], v[184:187], v[116:119], v[16:19]
    v_mfma_f32_16x16x32_bf16 v[20:23], v[188:191], v[116:119], v[20:23]
    s_add_u32 s5, s74, s36
    buffer_load_dwordx4 v[116:119], v2, s[60:63], s5 offen sc1
    s_waitcnt vmcnt(15)
    v_mfma_f32_16x16x32_bf16 v[24:27], v[172:175], v[120:123], v[24:27]
    v_mfma_f32_16x16x32_bf16 v[28:31], v[176:179], v[120:123], v[28:31]
    v_mfma_f32_16x16x32_bf16 v[32:35], v[180:183], v[120:123], v[32:35]
    v_mfma_f32_16x16x32_bf16 v[36:39], v[184:187], v[120:123], v[36:39]
    v_mfma_f32_16x16x32_bf16 v[40:43], v[188:191], v[120:123], v[40:43]
    s_add_u32 s5, s74, s37
    buffer_load_dwordx4 v[120:123], v2, s[60:63], s5 offen sc1
pad_g2_7:
    s_cbranch_execz pad_g2_8
    s_waitcnt vmcnt(15)
    v_mfma_f32_16x16x32_bf16 v[44:47], v[172:175], v[124:127], v[44:47]
    v_mfma_f32_16x16x32_bf16 v[48:51], v[176:179], v[124:127], v[48:51]
    v_mfma_f32_16x16x32_bf16 v[52:55], v[180:183], v[124:127], v[52:55]
    v_mfma_f32_16x16x32_bf16 v[56:59], v[184:187], v[124:127], v[56:59]
    v_mfma_f32_16x16x32_bf16 v[60:63], v[188:191], v[124:127], v[60:63]
    s_add_u32 s5, s74, s38
    buffer_load_dwordx4 v[124:127], v2, s[60:63], s5 offen sc1
    s_waitcnt vmcnt(15)
    v_mfma_f32_16x16x32_bf16 v[64:67], v[172:175], v[128:131], v[64:67]
    v_mfma_f32_16x16x32_bf16 v[68:71], v[176:179], v[128:131], v[68:71]
    v_mfma_f32_16x16x32_bf16 v[72:75], v[180:183], v[128:131], v[72:75]
    v_mfma_f32_16x16x32_bf16 v[76:79], v[184:187], v[128:131], v[76:79]
    v_mfma_f32_16x16x32_bf16 v[80:83], v[188:191], v[128:131], v[80:83]
    s_add_u32 s5, s74, s39
    buffer_load_dwordx4 v[128:131], v2, s[60:63], s5 offen sc1
    s_add_u32 s74, s74, 4096
pad_g2_8:
    s_cbranch_execz lw_done
    s_cmp_eq_u32 s74, s73
    s_cselect_b32 s74, s72, s74
    s_waitcnt vmcnt(15)
    v_mfma_f32_16x16x32_bf16 v[4:7], v[192:195], v[84:87], v[4:7]
    buffer_load_dwordx4 v[148:151], v2, s[60:63], s3 offen offset:0 sc1
    s_add_u32 s71, s71, 5120
    s_cmp_eq_u32 s71, s70
    s_cselect_b32 s71, s69, s71
    v_mfma_f32_16x16x32_bf16 v[8:11], v[196:199], v[84:87], v[8:11]
    s_add_u32 s3, s71, 4096
    buffer_load_dwordx4 v[152:155], v2, s[60:63], s71 offen offset:0 sc1
    v_mfma_f32_16x16x32_bf16 v[12:15], v[200:203], v[84:87], v[12:15]
    v_mfma_f32_16x16x32_bf16 v[16:19], v[204:207], v[84:87], v[16:19]
    v_mfma_f32_16x16x32_bf16 v[20:23], v[208:211], v[84:87], v[20:23]
    s_add_u32 s5, s74, s36
    buffer_load_dwordx4 v[84:87], v2, s[60:63], s5 offen sc1
    s_waitcnt vmcnt(17)
    v_mfma_f32_16x16x32_bf16 v[24:27], v[192:195], v[88:91], v[24:27]
    v_mfma_f32_16x16x32_bf16 v[28:31], v[196:199], v[88:91], v[28:31]
walk_15:
pad_g2_9:
    s_cbranch_execz pad_g2_10
    v_mfma_f32_16x16x32_bf16 v[32:35], v[200:203], v[88:91], v[32:35]
    v_mfma_f32_16x16x32_bf16 v[36:39], v[204:207], v[88:91], v[36:39]
    v_mfma_f32_16x16x32_bf16 v[40:43], v[208:211], v[88:91], v[40:43]
    s_add_u32 s5, s74, s37
    buffer_load_dwordx4 v[88:91], v2, s[60:63], s5 offen sc1
    s_waitcnt vmcnt(17)
    v_mfma_f32_16x16x32_bf16 v[44:47], v[192:195], v[92:95], v[44:47]
    v_mfma_f32_16x16x32_bf16 v[48:51], v[196:199], v[92:95], v[48:51]
    v_mfma_f32_16x16x32_bf16 v[52:55], v[200:203], v[92:95], v[52:55]
    v_mfma_f32_16x16x32_bf16 v[56:59], v[204:207], v[92:95], v[56:59]
    v_mfma_f32_16x16x32_bf16 v[60:63], v[208:211], v[92:95], v[60:63]
    s_add_u32 s5, s74, s38
    buffer_load_dwordx4 v[92:95], v2, s[60:63], s5 offen sc1
    s_waitcnt vmcnt(17)
    v_mfma_f32_16x16x32_bf16 v[64:67], v[192:195], v[96:99], v[64:67]
    v_mfma_f32_16x16x32_bf16 v[68:71], v[196:199], v[96:99], v[68:71]
    v_mfma_f32_16x16x32_bf16 v[72:75], v[200:203], v[96:99], v[72:75]
    v_mfma_f32_16x16x32_bf16 v[76:79], v[204:207], v[96:99], v[76:79]
pad_g2_10:
    s_cbranch_execz pad_g2_11
    v_mfma_f32_16x16x32_bf16 v[80:83], v[208:211], v[96:99], v[80:83]
    s_add_u32 s5, s74, s39
    buffer_load_dwordx4 v[96:99], v2, s[60:63], s5 offen sc1
    s_add_u32 s74, s74, 4096
    s_cmp_eq_u32 s74, s73
    s_cselect_b32 s74, s72, s74
    s_waitcnt vmcnt(15)
    v_mfma_f32_16x16x32_bf16 v[4:7], v[212:215], v[100:103], v[4:7]
    buffer_load_dwordx4 v[156:159], v2, s[60:63], s71 offen offset:1024 sc1
    v_mfma_f32_16x16x32_bf16 v[8:11], v[216:219], v[100:103], v[8:11]
    buffer_load_dwordx4 v[160:163], v2, s[60:63], s71 offen offset:2048 sc1
    v_mfma_f32_16x16x32_bf16 v[12:15], v[220:223], v[100:103], v[12:15]
    v_mfma_f32_16x16x32_bf16 v[16:19], v[224:227], v[100:103], v[16:19]
    v_mfma_f32_16x16x32_bf16 v[20:23], v[228:231], v[100:103], v[20:23]
    s_add_u32 s5, s74, s36
    buffer_load_dwordx4 v[100:103], v2, s[60:63], s5 offen sc1
    s_waitcnt vmcnt(17)
    v_mfma_f32_16x16x32_bf16 v[24:27], v[212:215], v[104:107], v[24:27]
pad_g2_11:
    s_cbranch_execz pad_g2_12
    v_mfma_f32_16x16x32_bf16 v[28:31], v[216:219], v[104:107], v[28:31]
    v_mfma_f32_16x16x32_bf16 v[32:35], v[220:223], v[104:107], v[32:35]
    v_mfma_f32_16x16x32_bf16 v[36:39], v[224:227], v[104:107], v[36:39]
    v_mfma_f32_16x16x32_bf16 v[40:43], v[228:231], v[104:107], v[40:43]
    s_add_u32 s5, s74, s37
    buffer_load_dwordx4 v[104:107], v2, s[60:63], s5 offen sc1
    s_waitcnt vmcnt(17)
    v_mfma_f32_16x16x32_bf16 v[44:47], v[212:215], v[108:111], v[44:47]
    v_mfma_f32_16x16x32_bf16 v[48:51], v[216:219], v[108:111], v[48:51]
    v_mfma_f32_16x16x32_bf16 v[52:55], v[220:223], v[108:111], v[52:55]
    v_mfma_f32_16x16x32_bf16 v[56:59], v[224:227], v[108:111], v[56:59]
    v_mfma_f32_16x16x32_bf16 v[60:63], v[228:231], v[108:111], v[60:63]
    s_add_u32 s5, s74, s38
    buffer_load_dwordx4 v[108:111], v2, s[60:63], s5 offen sc1
    s_waitcnt vmcnt(17)
    v_mfma_f32_16x16x32_bf16 v[64:67], v[212:215], v[112:115], v[64:67]
    v_mfma_f32_16x16x32_bf16 v[68:71], v[216:219], v[112:115], v[68:71]
    v_mfma_f32_16x16x32_bf16 v[72:75], v[220:223], v[112:115], v[72:75]
pad_g2_12:
    s_cbranch_execz pad_g2_13
    v_mfma_f32_16x16x32_bf16 v[76:79], v[224:227], v[112:115], v[76:79]
    v_mfma_f32_16x16x32_bf16 v[80:83], v[228:231], v[112:115], v[80:83]
    s_add_u32 s5, s74, s39
    buffer_load_dwordx4 v[112:115], v2, s[60:63], s5 offen sc1
    s_add_u32 s74, s74, 4096
    s_cmp_eq_u32 s74, s73
    s_cselect_b32 s74, s72, s74
    s_waitcnt vmcnt(15)
    v_mfma_f32_16x16x32_bf16 v[4:7], v[232:235], v[116:119], v[4:7]
    buffer_load_dwordx4 v[164:167], v2, s[60:63], s71 offen offset:3072 sc1
    v_mfma_f32_16x16x32_bf16 v[8:11], v[236:239], v[116:119], v[8:11]
    buffer_load_dwordx4 v[168:171], v2, s[60:63], s3 offen offset:0 sc1
    s_add_u32 s71, s71, 5120
    s_cmp_eq_u32 s71, s70
    s_cselect_b32 s71, s69, s71
    v_mfma_f32_16x16x32_bf16 v[12:15], v[240:243], v[116:119], v[12:15]
    ds_read_b128 v[212:215], v3 offset:0
    v_mfma_f32_16x16x32_bf16 v[16:19], v[244:247], v[116:119], v[16:19]
pad_g2_13:
    s_cbranch_execz pad_g2_14
    ds_read_b128 v[216:219], v3 offset:1024
    v_mfma_f32_16x16x32_bf16 v[20:23], v[248:251], v[116:119], v[20:23]
    ds_read_b128 v[220:223], v3 offset:2048
    s_add_u32 s5, s74, s36
    buffer_load_dwordx4 v[116:119], v2, s[60:63], s5 offen sc1
    s_waitcnt vmcnt(17)
    v_mfma_f32_16x16x32_bf16 v[24:27], v[232:235], v[120:123], v[24:27]
    ds_read_b128 v[224:227], v3 offset:3072
    v_mfma_f32_16x16x32_bf16 v[28:31], v[236:239], v[120:123], v[28:31]
    ds_read_b128 v[228:231], v3 offset:4096
    v_mfma_f32_16x16x32_bf16 v[32:35], v[240:243], v[120:123], v[32:35]
    v_mfma_f32_16x16x32_bf16 v[36:39], v[244:247], v[120:123], v[36:39]
    v_mfma_f32_16x16x32_bf16 v[40:43], v[248:251], v[120:123], v[40:43]
    s_add_u32 s5, s74, s37
    buffer_load_dwordx4 v[120:123], v2, s[60:63], s5 offen sc1
    s_waitcnt vmcnt(17)
    v_mfma_f32_16x16x32_bf16 v[44:47], v[232:235], v[124:127], v[44:47]
    v_mfma_f32_16x16x32_bf16 v[48:51], v[236:239], v[124:127], v[48:51]
pad_g2_14:
    s_cbranch_execz pad_g2_15
    v_mfma_f32_16x16x32_bf16 v[52:55], v[240:243], v[124:127], v[52:55]
    v_mfma_f32_16x16x32_bf16 v[56:59], v[244:247], v[124:127], v[56:59]
    v_mfma_f32_16x16x32_bf16 v[60:63], v[248:251], v[124:127], v[60:63]
    s_add_u32 s5, s74, s38
    buffer_load_dwordx4 v[124:127], v2, s[60:63], s5 offen sc1
    s_waitcnt vmcnt(17)
    v_mfma_f32_16x16x32_bf16 v[64:67], v[232:235], v[128:131], v[64:67]
    v_mfma_f32_16x16x32_bf16 v[68:71], v[236:239], v[128:131], v[68:71]
    v_mfma_f32_16x16x32_bf16 v[72:75], v[240:243], v[128:131], v[72:75]
    v_mfma_f32_16x16x32_bf16 v[76:79], v[244:247], v[128:131], v[76:79]
    v_mfma_f32_16x16x32_bf16 v[80:83], v[248:251], v[128:131], v[80:83]
    s_add_u32 s5, s74, s39
    buffer_load_dwordx4 v[128:131], v2, s[60:63], s5 offen sc1
    s_add_u32 s74, s74, 4096
    s_cmp_eq_u32 s74, s73
    s_cselect_b32 s74, s72, s74
    s_waitcnt lgkmcnt(0)
    s_waitcnt vmcnt(15)
    v_mfma_f32_16x16x32_bf16 v[4:7], v[212:215], v[84:87], v[4:7]
pad_g2_15:
    s_cbranch_execz pad_g2_16
    s_add_u32 s3, s71, 4096
    buffer_load_dwordx4 v[172:175], v2, s[60:63], s71 offen offset:0 sc1
    v_mfma_f32_16x16x32_bf16 v[8:11], v[216:219], v[84:87], v[8:11]
    buffer_load_dwordx4 v[176:179], v2, s[60:63], s71 offen offset:1024 sc1
    v_mfma_f32_16x16x32_bf16 v[12:15], v[220:223], v[84:87], v[12:15]
    ds_read_b128 v[232:235], v3 offset:5120
    v_mfma_f32_16x16x32_bf16 v[16:19], v[224:227], v[84:87], v[16:19]
    ds_read_b128 v[236:239], v3 offset:6144
    v_mfma_f32_16x16x32_bf16 v[20:23], v[228:231], v[84:87], v[20:23]
    ds_read_b128 v[240:243], v3 offset:7168
    s_add_u32 s5, s74, s36
    buffer_load_dwordx4 v[84:87], v2, s[60:63], s5 offen sc1
    s_waitcnt vmcnt(17)
    v_mfma_f32_16x16x32_bf16 v[24:27], v[212:215], v[88:91], v[24:27]
    ds_read_b128 v[244:247], v3 offset:8192
    v_mfma_f32_16x16x32_bf16 v[28:31], v[216:219], v[88:91], v[28:31]
pad_g2_16:
    s_cbranch_execz pad_g2_17
    ds_read_b128 v[248:251], v3 offset:9216
    v_mfma_f32_16x16x32_bf16 v[32:35], v[220:223], v[88:91], v[32:35]
    v_mfma_f32_16x16x32_bf16 v[36:39], v[224:227], v[88:91], v[36:39]
    v_mfma_f32_16x16x32_bf16 v[40:43], v[228:231], v[88:91], v[40:43]
    s_add_u32 s5, s74, s37
    buffer_load_dwordx4 v[88:91], v2, s[60:63], s5 offen sc1
    s_waitcnt vmcnt(17)
    v_mfma_f32_16x16x32_bf16 v[44:47], v[212:215], v[92:95], v[44:47]
    v_mfma_f32_16x16x32_bf16 v[48:51], v[216:219], v[92:95], v[48:51]
    v_mfma_f32_16x16x32_bf16 v[52:55], v[220:223], v[92:95], v[52:55]
    v_mfma_f32_16x16x32_bf16 v[56:59], v[224:227], v[92:95], v[56:59]
    v_mfma_f32_16x16x32_bf16 v[60:63], v[228:231], v[92:95], v[60:63]
    s_add_u32 s5, s74, s38
    buffer_load_dwordx4 v[92:95], v2, s[60:63], s5 offen sc1
    s_waitcnt vmcnt(17)
    v_mfma_f32_16x16x32_bf16 v[64:67], v[212:215], v[96:99], v[64:67]
    v_mfma_f32_16x16x32_bf16 v[68:71], v[216:219], v[96:99], v[68:71]
    v_mfma_f32_16x16x32_bf16 v[72:75], v[220:223], v[96:99], v[72:75]
pad_g2_17:
    s_cbranch_execz lw_done
    v_mfma_f32_16x16x32_bf16 v[76:79], v[224:227], v[96:99], v[76:79]
    v_mfma_f32_16x16x32_bf16 v[80:83], v[228:231], v[96:99], v[80:83]
    s_add_u32 s5, s74, s39
    buffer_load_dwordx4 v[96:99], v2, s[60:63], s5 offen sc1
    s_add_u32 s74, s74, 4096
    s_cmp_eq_u32 s74, s73
    s_cselect_b32 s74, s72, s74
    s_waitcnt lgkmcnt(0)
    s_waitcnt vmcnt(15)
    v_mfma_f32_16x16x32_bf16 v[4:7], v[232:235], v[100:103], v[4:7]
    buffer_load_dwordx4 v[180:183], v2, s[60:63], s71 offen offset:2048 sc1
    v_mfma_f32_16x16x32_bf16 v[8:11], v[236:239], v[100:103], v[8:11]
    buffer_load_dwordx4 v[184:187], v2, s[60:63], s71 offen offset:3072 sc1
    v_mfma_f32_16x16x32_bf16 v[12:15], v[240:243], v[100:103], v[12:15]
    ds_read_b128 v[212:215], v3 offset:10240
    v_mfma_f32_16x16x32_bf16 v[16:19], v[244:247], v[100:103], v[16:19]
    ds_read_b128 v[216:219], v3 offset:11264
    v_mfma_f32_16x16x32_bf16 v[20:23], v[248:251], v[100:103], v[20:23]
walk_16:
pad_g2_18:
    s_cbranch_execz pad_g2_19
    ds_read_b128 v[220:223], v3 offset:12288
    s_add_u32 s5, s74, s36
    buffer_load_dwordx4 v[100:103], v2, s[60:63], s5 offen sc1
    s_waitcnt vmcnt(17)
    v_mfma_f32_16x16x32_bf16 v[24:27], v[232:235], v[104:107], v[24:27]
    ds_read_b128 v[224:227], v3 offset:13312
    v_mfma_f32_16x16x32_bf16 v[28:31], v[236:239], v[104:107], v[28:31]
    ds_read_b128 v[228:231], v3 offset:14336
    v_mfma_f32_16x16x32_bf16 v[32:35], v[240:243], v[104:107], v[32:35]
    s_and_b32 s4, s6, 3
    s_lshl2_add_u32 s4, s4, 0
    v_mov_b32 v254, s4
    v_add_u32 v254, 163328, v254
    v_mov_b32 v255, 1
    ds_write_b32 v254, v255
    v_mfma_f32_16x16x32_bf16 v[36:39], v[244:247], v[104:107], v[36:39]
    v_mfma_f32_16x16x32_bf16 v[40:43], v[248:251], v[104:107], v[40:43]
    s_add_u32 s5, s74, s37
    buffer_load_dwordx4 v[104:107], v2, s[60:63], s5 offen sc1
pad_g2_19:
    s_cbranch_execz pad_g2_20
    s_waitcnt vmcnt(17)
    v_mfma_f32_16x16x32_bf16 v[44:47], v[232:235], v[108:111], v[44:47]
    v_mfma_f32_16x16x32_bf16 v[48:51], v[236:239], v[108:111], v[48:51]
    v_mfma_f32_16x16x32_bf16 v[52:55], v[240:243], v[108:111], v[52:55]
    v_mfma_f32_16x16x32_bf16 v[56:59], v[244:247], v[108:111], v[56:59]
    v_mfma_f32_16x16x32_bf16 v[60:63], v[248:251], v[108:111], v[60:63]
    s_add_u32 s5, s74, s38
    buffer_load_dwordx4 v[108:111], v2, s[60:63], s5 offen sc1
    s_waitcnt vmcnt(17)
    v_mfma_f32_16x16x32_bf16 v[64:67], v[232:235], v[112:115], v[64:67]
    v_mfma_f32_16x16x32_bf16 v[68:71], v[236:239], v[112:115], v[68:71]
    v_mfma_f32_16x16x32_bf16 v[72:75], v[240:243], v[112:115], v[72:75]
    v_mfma_f32_16x16x32_bf16 v[76:79], v[244:247], v[112:115], v[76:79]
    v_mfma_f32_16x16x32_bf16 v[80:83], v[248:251], v[112:115], v[80:83]
    s_add_u32 s5, s74, s39
    buffer_load_dwordx4 v[112:115], v2, s[60:63], s5 offen sc1
    s_add_u32 s74, s74, 4096
pad_g2_20:
    s_cbranch_execz pad_g2_21
    s_cmp_eq_u32 s74, s73
    s_cselect_b32 s74, s72, s74
    s_waitcnt lgkmcnt(0)
    s_waitcnt vmcnt(15)
    v_mfma_f32_16x16x32_bf16 v[4:7], v[212:215], v[116:119], v[4:7]
    buffer_load_dwordx4 v[188:191], v2, s[60:63], s3 offen offset:0 sc1
    s_add_u32 s71, s71, 5120
    s_cmp_eq_u32 s71, s70
    s_cselect_b32 s71, s69, s71
    v_mfma_f32_16x16x32_bf16 v[8:11], v[216:219], v[116:119], v[8:11]
    s_cmp_eq_u32 s68, 13
    s_cselect_b32 s71, 0x1a00000, s71
    s_add_u32 s3, s71, 4096
    buffer_load_dwordx4 v[192:195], v2, s[60:63], s71 offen offset:0 sc1
    v_mfma_f32_16x16x32_bf16 v[12:15], v[220:223], v[116:119], v[12:15]
    ds_read_b128 v[232:235], v3 offset:15360
    v_mfma_f32_16x16x32_bf16 v[16:19], v[224:227], v[116:119], v[16:19]
    ds_read_b128 v[236:239], v3 offset:16384
    v_mfma_f32_16x16x32_bf16 v[20:23], v[228:231], v[116:119], v[20:23]
pad_g2_21:
    s_cbranch_execz pad_g2_22
    ds_read_b128 v[240:243], v3 offset:17408
    s_add_u32 s5, s74, s36
    buffer_load_dwordx4 v[116:119], v2, s[60:63], s5 offen sc1
    s_waitcnt vmcnt(17)
    v_mfma_f32_16x16x32_bf16 v[24:27], v[212:215], v[120:123], v[24:27]
    ds_read_b128 v[244:247], v3 offset:18432
    v_mfma_f32_16x16x32_bf16 v[28:31], v[216:219], v[120:123], v[28:31]
    ds_read_b128 v[248:251], v3 offset:19456
    v_mfma_f32_16x16x32_bf16 v[32:35], v[220:223], v[120:123], v[32:35]
    v_mfma_f32_16x16x32_bf16 v[36:39], v[224:227], v[120:123], v[36:39]
    v_mfma_f32_16x16x32_bf16 v[40:43], v[228:231], v[120:123], v[40:43]
    s_add_u32 s5, s74, s37
    buffer_load_dwordx4 v[120:123], v2, s[60:63], s5 offen sc1
    s_waitcnt vmcnt(17)
    v_mfma_f32_16x16x32_bf16 v[44:47], v[212:215], v[124:127], v[44:47]
    v_mfma_f32_16x16x32_bf16 v[48:51], v[216:219], v[124:127], v[48:51]
    v_mfma_f32_16x16x32_bf16 v[52:55], v[220:223], v[124:127], v[52:55]
    v_mfma_f32_16x16x32_bf16 v[56:59], v[224:227], v[124:127], v[56:59]
pad_g2_22:
    s_cbranch_execz pad_g2_23
    v_mfma_f32_16x16x32_bf16 v[60:63], v[228:231], v[124:127], v[60:63]
    s_add_u32 s5, s74, s38
    buffer_load_dwordx4 v[124:127], v2, s[60:63], s5 offen sc1
    s_waitcnt vmcnt(17)
    v_mfma_f32_16x16x32_bf16 v[64:67], v[212:215], v[128:131], v[64:67]
    v_mfma_f32_16x16x32_bf16 v[68:71], v[216:219], v[128:131], v[68:71]
    v_mfma_f32_16x16x32_bf16 v[72:75], v[220:223], v[128:131], v[72:75]
    v_mfma_f32_16x16x32_bf16 v[76:79], v[224:227], v[128:131], v[76:79]
    v_mfma_f32_16x16x32_bf16 v[80:83], v[228:231], v[128:131], v[80:83]
    s_add_u32 s5, s74, s39
    buffer_load_dwordx4 v[128:131], v2, s[60:63], s5 offen sc1
    s_add_u32 s74, s74, 4096
    s_cmp_eq_u32 s74, s73
    s_cselect_b32 s74, s72, s74
    s_waitcnt lgkmcnt(0)
    s_waitcnt vmcnt(15)
    v_mfma_f32_16x16x32_bf16 v[4:7], v[232:235], v[84:87], v[4:7]
    buffer_load_dwordx4 v[196:199], v2, s[60:63], s71 offen offset:1024 sc1
    v_mfma_f32_16x16x32_bf16 v[8:11], v[236:239], v[84:87], v[8:11]
pad_g2_23:
    s_cbranch_execz pad_g2_24
    buffer_load_dwordx4 v[200:203], v2, s[60:63], s71 offen offset:2048 sc1
    v_mfma_f32_16x16x32_bf16 v[12:15], v[240:243], v[84:87], v[12:15]
    v_mfma_f32_16x16x32_bf16 v[16:19], v[244:247], v[84:87], v[16:19]
    v_mfma_f32_16x16x32_bf16 v[20:23], v[248:251], v[84:87], v[20:23]
    s_add_u32 s5, s74, s36
    buffer_load_dwordx4 v[84:87], v2, s[60:63], s5 offen sc1
    s_waitcnt vmcnt(17)
    v_mfma_f32_16x16x32_bf16 v[24:27], v[232:235], v[88:91], v[24:27]
    v_mfma_f32_16x16x32_bf16 v[28:31], v[236:239], v[88:91], v[28:31]
    v_mfma_f32_16x16x32_bf16 v[32:35], v[240:243], v[88:91], v[32:35]
    v_mfma_f32_16x16x32_bf16 v[36:39], v[244:247], v[88:91], v[36:39]
    v_mfma_f32_16x16x32_bf16 v[40:43], v[248:251], v[88:91], v[40:43]
    s_add_u32 s5, s74, s37
    buffer_load_dwordx4 v[88:91], v2, s[60:63], s5 offen sc1
    s_waitcnt vmcnt(17)
    v_mfma_f32_16x16x32_bf16 v[44:47], v[232:235], v[92:95], v[44:47]
    v_mfma_f32_16x16x32_bf16 v[48:51], v[236:239], v[92:95], v[48:51]
pad_g2_24:
    s_cbranch_execz pad_g2_25
    v_mfma_f32_16x16x32_bf16 v[52:55], v[240:243], v[92:95], v[52:55]
    v_mfma_f32_16x16x32_bf16 v[56:59], v[244:247], v[92:95], v[56:59]
    v_mfma_f32_16x16x32_bf16 v[60:63], v[248:251], v[92:95], v[60:63]
    s_add_u32 s5, s74, s38
    buffer_load_dwordx4 v[92:95], v2, s[60:63], s5 offen sc1
    s_waitcnt vmcnt(17)
    v_mfma_f32_16x16x32_bf16 v[64:67], v[232:235], v[96:99], v[64:67]
    v_mfma_f32_16x16x32_bf16 v[68:71], v[236:239], v[96:99], v[68:71]
    v_mfma_f32_16x16x32_bf16 v[72:75], v[240:243], v[96:99], v[72:75]
    v_mfma_f32_16x16x32_bf16 v[76:79], v[244:247], v[96:99], v[76:79]
    v_mfma_f32_16x16x32_bf16 v[80:83], v[248:251], v[96:99], v[80:83]
    s_add_u32 s5, s74, s39
    buffer_load_dwordx4 v[96:99], v2, s[60:63], s5 offen sc1
    s_add_u32 s74, s74, 4096
    s_cmp_eq_u32 s74, s73
    s_cselect_b32 s74, s72, s74
    s_cmp_eq_u32 s68, 13
    s_cselect_b32 s74, 0x1a00000, s74
    s_waitcnt vmcnt(15)
pad_g2_25:
    s_cbranch_execz pad_g2_26
    v_mfma_f32_16x16x32_bf16 v[4:7], v[132:135], v[100:103], v[4:7]
    buffer_load_dwordx4 v[204:207], v2, s[60:63], s71 offen offset:3072 sc1
    v_mfma_f32_16x16x32_bf16 v[8:11], v[136:139], v[100:103], v[8:11]
    buffer_load_dwordx4 v[208:211], v2, s[60:63], s3 offen offset:0 sc1
    v_mfma_f32_16x16x32_bf16 v[12:15], v[140:143], v[100:103], v[12:15]
    s_add_u32 s4, s6, 3
    s_and_b32 s4, s4, 3
    s_mul_i32 s4, s4, 20480
    v_add_u32 v212, s4, v2
    v_mfma_f32_16x16x32_bf16 v[16:19], v[144:147], v[100:103], v[16:19]
    s_add_u32 s4, s6, 2
    s_and_b32 s4, s4, 3
    s_mul_i32 s4, s4, 20480
    v_add_u32 v213, s4, v2
    v_mfma_f32_16x16x32_bf16 v[20:23], v[148:151], v[100:103], v[20:23]
    s_add_u32 s4, s6, 1
    s_and_b32 s4, s4, 3
    s_mul_i32 s4, s4, 20480
    v_add_u32 v214, s4, v2
    s_add_u32 s5, s74, s36
    buffer_load_dwordx4 v[100:103], v2, s[60:63], s5 offen sc1
pad_g2_26:
    s_cbranch_execz lw_done
    s_waitcnt vmcnt(17)
    v_mfma_f32_16x16x32_bf16 v[24:27], v[132:135], v[104:107], v[24:27]
    v_lshrrev_b32 v221, 4, v1
    v_mfma_f32_16x16x32_bf16 v[28:31], v[136:139], v[104:107], v[28:31]
    v_bfe_u32 v217, v1, 2, 2
    v_mfma_f32_16x16x32_bf16 v[32:35], v[140:143], v[104:107], v[32:35]
    v_lshl_add_u32 v217, v221, 2, v217
    v_mfma_f32_16x16x32_bf16 v[36:39], v[144:147], v[104:107], v[36:39]
    v_mul_u32_u24 v217, 144, v217
    v_mfma_f32_16x16x32_bf16 v[40:43], v[148:151], v[104:107], v[40:43]
    v_and_b32 v220, 3, v1
    s_add_u32 s5, s74, s37
    buffer_load_dwordx4 v[104:107], v2, s[60:63], s5 offen sc1
    s_waitcnt vmcnt(17)
    v_mfma_f32_16x16x32_bf16 v[44:47], v[132:135], v[108:111], v[44:47]
    v_lshl_add_u32 v217, v220, 3, v217
    v_mfma_f32_16x16x32_bf16 v[48:51], v[136:139], v[108:111], v[48:51]
    s_lshr_b32 s4, s39, 5
walk_17:
pad_g2_27:
    s_cbranch_execz pad_g2_28
    s_add_u32 s4, s4, s75
    v_add_u32 v217, s4, v217
    v_mfma_f32_16x16x32_bf16 v[52:55], v[140:143], v[108:111], v[52:55]
    v_mfma_f32_16x16x32_bf16 v[56:59], v[144:147], v[108:111], v[56:59]
    v_mfma_f32_16x16x32_bf16 v[60:63], v[148:151], v[108:111], v[60:63]
    s_add_u32 s5, s74, s38
    buffer_load_dwordx4 v[108:111], v2, s[60:63], s5 offen sc1
    s_waitcnt vmcnt(17)
    v_mfma_f32_16x16x32_bf16 v[64:67], v[132:135], v[112:115], v[64:67]
    v_mfma_f32_16x16x32_bf16 v[68:71], v[136:139], v[112:115], v[68:71]
    v_mfma_f32_16x16x32_bf16 v[72:75], v[140:143], v[112:115], v[72:75]
    v_mfma_f32_16x16x32_bf16 v[76:79], v[144:147], v[112:115], v[76:79]
    v_mfma_f32_16x16x32_bf16 v[80:83], v[148:151], v[112:115], v[80:83]
    s_add_u32 s5, s74, s39
    buffer_load_dwordx4 v[112:115], v2, s[60:63], s5 offen sc1
    s_waitcnt vmcnt(15)
    v_mfma_f32_16x16x32_bf16 v[4:7], v[152:155], v[116:119], v[4:7]
    v_mul_u32_u24 v215, 576, v221
    v_mfma_f32_16x16x32_bf16 v[8:11], v[156:159], v[116:119], v[8:11]
pad_g2_28:
    s_cbranch_execz pad_g2_29
    v_add_u32 v215, v215, v217
    v_mfma_f32_16x16x32_bf16 v[12:15], v[160:163], v[116:119], v[12:15]
    v_and_b32 v220, 15, v1
    v_mfma_f32_16x16x32_bf16 v[16:19], v[164:167], v[116:119], v[16:19]
    s_lshr_b32 s4, s39, 6
    v_add_u32 v220, s4, v220
    v_mfma_f32_16x16x32_bf16 v[20:23], v[168:171], v[116:119], v[20:23]
    s_add_u32 s4, s75, 11520
    v_lshl_add_u32 v218, v220, 2, s4
    s_waitcnt vmcnt(14)
    v_mfma_f32_16x16x32_bf16 v[24:27], v[152:155], v[120:123], v[24:27]
    v_mul_u32_u24 v224, 1280, v220
    v_mfma_f32_16x16x32_bf16 v[28:31], v[156:159], v[120:123], v[28:31]
    v_lshl_add_u32 v224, v221, 3, v224
    v_mfma_f32_16x16x32_bf16 v[32:35], v[160:163], v[120:123], v[32:35]
    s_mul_i32 s4, s13, 81920
    v_add_u32 v224, s4, v224
    v_mfma_f32_16x16x32_bf16 v[36:39], v[164:167], v[120:123], v[36:39]
pad_g2_29:
    s_cbranch_execz pad_g2_30
    s_mul_i32 s4, s14, 160
    v_add_u32 v224, s4, v224
    v_mfma_f32_16x16x32_bf16 v[40:43], v[168:171], v[120:123], v[40:43]
    v_lshl_add_u32 v216, v221, 3, v224
    s_waitcnt vmcnt(13)
    v_mfma_f32_16x16x32_bf16 v[44:47], v[152:155], v[124:127], v[44:47]
    v_mfma_f32_16x16x32_bf16 v[48:51], v[156:159], v[124:127], v[48:51]
    v_mfma_f32_16x16x32_bf16 v[52:55], v[160:163], v[124:127], v[52:55]
    v_mfma_f32_16x16x32_bf16 v[56:59], v[164:167], v[124:127], v[56:59]
    v_mfma_f32_16x16x32_bf16 v[60:63], v[168:171], v[124:127], v[60:63]
    s_waitcnt vmcnt(12)
    v_mfma_f32_16x16x32_bf16 v[64:67], v[152:155], v[128:131], v[64:67]
    v_mfma_f32_16x16x32_bf16 v[68:71], v[156:159], v[128:131], v[68:71]
    v_mfma_f32_16x16x32_bf16 v[72:75], v[160:163], v[128:131], v[72:75]
    v_mfma_f32_16x16x32_bf16 v[76:79], v[164:167], v[128:131], v[76:79]
    v_mfma_f32_16x16x32_bf16 v[80:83], v[168:171], v[128:131], v[80:83]
    s_cmp_eq_u32 s68, 13
    s_cbranch_scc1 g2_short
pad_g2_30:
    s_cbranch_execz pad_g2_31
    s_waitcnt vmcnt(9)
    v_mfma_f32_16x16x32_bf16 v[4:7], v[172:175], v[84:87], v[4:7]
    v_mfma_f32_16x16x32_bf16 v[8:11], v[176:179], v[84:87], v[8:11]
    v_mfma_f32_16x16x32_bf16 v[12:15], v[180:183], v[84:87], v[12:15]
    v_mfma_f32_16x16x32_bf16 v[16:19], v[184:187], v[84:87], v[16:19]
    v_mfma_f32_16x16x32_bf16 v[20:23], v[188:191], v[84:87], v[20:23]
    s_waitcnt vmcnt(8)
    v_mfma_f32_16x16x32_bf16 v[24:27], v[172:175], v[88:91], v[24:27]
    v_mfma_f32_16x16x32_bf16 v[28:31], v[176:179], v[88:91], v[28:31]
    v_mfma_f32_16x16x32_bf16 v[32:35], v[180:183], v[88:91], v[32:35]
    v_mfma_f32_16x16x32_bf16 v[36:39], v[184:187], v[88:91], v[36:39]
    v_mfma_f32_16x16x32_bf16 v[40:43], v[188:191], v[88:91], v[40:43]
    s_waitcnt vmcnt(7)
    v_mfma_f32_16x16x32_bf16 v[44:47], v[172:175], v[92:95], v[44:47]
    v_mfma_f32_16x16x32_bf16 v[48:51], v[176:179], v[92:95], v[48:51]
    v_mfma_f32_16x16x32_bf16 v[52:55], v[180:183], v[92:95], v[52:55]
    v_mfma_f32_16x16x32_bf16 v[56:59], v[184:187], v[92:95], v[56:59]
pad_g2_31:
    s_cbranch_execz pad_g2_32
    v_mfma_f32_16x16x32_bf16 v[60:63], v[188:191], v[92:95], v[60:63]
    s_waitcnt vmcnt(6)
    v_mfma_f32_16x16x32_bf16 v[64:67], v[172:175], v[96:99], v[64:67]
    v_mfma_f32_16x16x32_bf16 v[68:71], v[176:179], v[96:99], v[68:71]
    v_mfma_f32_16x16x32_bf16 v[72:75], v[180:183], v[96:99], v[72:75]
    v_mfma_f32_16x16x32_bf16 v[76:79], v[184:187], v[96:99], v[76:79]
    v_mfma_f32_16x16x32_bf16 v[80:83], v[188:191], v[96:99], v[80:83]
    s_waitcnt vmcnt(3)
    v_mfma_f32_16x16x32_bf16 v[4:7], v[192:195], v[100:103], v[4:7]
    v_mfma_f32_16x16x32_bf16 v[8:11], v[196:199], v[100:103], v[8:11]
    v_mfma_f32_16x16x32_bf16 v[12:15], v[200:203], v[100:103], v[12:15]
    v_mfma_f32_16x16x32_bf16 v[16:19], v[204:207], v[100:103], v[16:19]
    v_mfma_f32_16x16x32_bf16 v[20:23], v[208:211], v[100:103], v[20:23]
    s_waitcnt vmcnt(2)
    v_mfma_f32_16x16x32_bf16 v[24:27], v[192:195], v[104:107], v[24:27]
    s_nop 1
    ds_write_b128 v3, v[4:7] offset:0
    v_mfma_f32_16x16x32_bf16 v[28:31], v[196:199], v[104:107], v[28:31]
pad_g2_32:
    s_cbranch_execz pad_g2_33
    ds_write_b128 v3, v[8:11] offset:1024
    v_mfma_f32_16x16x32_bf16 v[32:35], v[200:203], v[104:107], v[32:35]
    ds_write_b128 v3, v[12:15] offset:2048
    v_mfma_f32_16x16x32_bf16 v[36:39], v[204:207], v[104:107], v[36:39]
    ds_write_b128 v3, v[16:19] offset:3072
    v_mfma_f32_16x16x32_bf16 v[40:43], v[208:211], v[104:107], v[40:43]
    ds_write_b128 v3, v[20:23] offset:4096
    s_waitcnt vmcnt(1)
    v_mfma_f32_16x16x32_bf16 v[44:47], v[192:195], v[108:111], v[44:47]
    ds_write_b128 v3, v[24:27] offset:5120
    v_mfma_f32_16x16x32_bf16 v[48:51], v[196:199], v[108:111], v[48:51]
    ds_write_b128 v3, v[28:31] offset:6144
    v_mfma_f32_16x16x32_bf16 v[52:55], v[200:203], v[108:111], v[52:55]
    ds_write_b128 v3, v[32:35] offset:7168
    v_mfma_f32_16x16x32_bf16 v[56:59], v[204:207], v[108:111], v[56:59]
    ds_write_b128 v3, v[36:39] offset:8192
pad_g2_33:
    s_cbranch_execz pad_g2_34
    v_mfma_f32_16x16x32_bf16 v[60:63], v[208:211], v[108:111], v[60:63]
    ds_write_b128 v3, v[40:43] offset:9216
    s_waitcnt vmcnt(0)
    v_mfma_f32_16x16x32_bf16 v[72:75], v[200:203], v[112:115], v[72:75]
    ds_write_b128 v3, v[44:47] offset:10240
    v_mfma_f32_16x16x32_bf16 v[76:79], v[204:207], v[112:115], v[76:79]
    ds_write_b128 v3, v[48:51] offset:11264
    v_mfma_f32_16x16x32_bf16 v[80:83], v[208:211], v[112:115], v[80:83]
    ds_write_b128 v3, v[52:55] offset:12288
    v_mfma_f32_16x16x32_bf16 v[64:67], v[192:195], v[112:115], v[64:67]
    ds_write_b128 v3, v[56:59] offset:13312
    v_mfma_f32_16x16x32_bf16 v[68:71], v[196:199], v[112:115], v[68:71]
    ds_write_b128 v3, v[60:63] offset:14336
    ds_write_b128 v3, v[72:75] offset:17408
    ds_write_b128 v3, v[76:79] offset:18432
    s_nop 0
pad_g2_34:
    s_cbranch_execz pad_g2_35
    ds_write_b128 v3, v[80:83] offset:19456
    s_branch g2_last
g2_short:
    s_waitcnt vmcnt(9)
    v_mfma_f32_16x16x32_bf16 v[4:7], v[172:175], v[84:87], v[4:7]
    v_mfma_f32_16x16x32_bf16 v[8:11], v[176:179], v[84:87], v[8:11]
    v_mfma_f32_16x16x32_bf16 v[12:15], v[180:183], v[84:87], v[12:15]
    v_mfma_f32_16x16x32_bf16 v[16:19], v[184:187], v[84:87], v[16:19]
    v_mfma_f32_16x16x32_bf16 v[20:23], v[188:191], v[84:87], v[20:23]
    s_waitcnt vmcnt(8)
    v_mfma_f32_16x16x32_bf16 v[24:27], v[172:175], v[88:91], v[24:27]
    s_nop 1
    ds_write_b128 v3, v[4:7] offset:0
    v_mfma_f32_16x16x32_bf16 v[28:31], v[176:179], v[88:91], v[28:31]
    ds_write_b128 v3, v[8:11] offset:1024
    v_mfma_f32_16x16x32_bf16 v[32:35], v[180:183], v[88:91], v[32:35]
    ds_write_b128 v3, v[12:15] offset:2048
    v_mfma_f32_16x16x32_bf16 v[36:39], v[184:187], v[88:91], v[36:39]
    ds_write_b128 v3, v[16:19] offset:3072
pad_g2_35:
    s_cbranch_execz pad_g2_36
    v_mfma_f32_16x16x32_bf16 v[40:43], v[188:191], v[88:91], v[40:43]
    ds_write_b128 v3, v[20:23] offset:4096
    s_waitcnt vmcnt(7)
    v_mfma_f32_16x16x32_bf16 v[44:47], v[172:175], v[92:95], v[44:47]
    ds_write_b128 v3, v[24:27] offset:5120
    v_mfma_f32_16x16x32_bf16 v[48:51], v[176:179], v[92:95], v[48:51]
    ds_write_b128 v3, v[28:31] offset:6144
    v_mfma_f32_16x16x32_bf16 v[52:55], v[180:183], v[92:95], v[52:55]
    ds_write_b128 v3, v[32:35] offset:7168
    v_mfma_f32_16x16x32_bf16 v[56:59], v[184:187], v[92:95], v[56:59]
    ds_write_b128 v3, v[36:39] offset:8192
    v_mfma_f32_16x16x32_bf16 v[60:63], v[188:191], v[92:95], v[60:63]
    ds_write_b128 v3, v[40:43] offset:9216
    s_waitcnt vmcnt(6)
    v_mfma_f32_16x16x32_bf16 v[72:75], v[180:183], v[96:99], v[72:75]
    ds_write_b128 v3, v[44:47] offset:10240
pad_g2_36:
    s_cbranch_execz lw_done
    v_mfma_f32_16x16x32_bf16 v[76:79], v[184:187], v[96:99], v[76:79]
    ds_write_b128 v3, v[48:51] offset:11264
    v_mfma_f32_16x16x32_bf16 v[80:83], v[188:191], v[96:99], v[80:83]
    ds_write_b128 v3, v[52:55] offset:12288
    v_mfma_f32_16x16x32_bf16 v[64:67], v[172:175], v[96:99], v[64:67]
    ds_write_b128 v3, v[56:59] offset:13312
    v_mfma_f32_16x16x32_bf16 v[68:71], v[176:179], v[96:99], v[68:71]
    ds_write_b128 v3, v[60:63] offset:14336
    ds_write_b128 v3, v[72:75] offset:17408
    ds_write_b128 v3, v[76:79] offset:18432
    s_nop 0
    ds_write_b128 v3, v[80:83] offset:19456
g2_last:
final:
pad_fin_0:
    s_cbranch_execz pad_fin_1
    s_waitcnt lgkmcnt(0)
    s_cmp_lt_u32 s6, 4
    s_barrier
    s_cbranch_scc1 fin_mate
    ds_read_b32 v84, v218
    ds_read_b64_tr_b16 v[86:87], v215 offset:0
pad_fin_1:
    s_cbranch_execz pad_fin_2
    ds_read_b64_tr_b16 v[88:89], v215 offset:576
    ds_read_b128 v[4:7], v212 offset:0
    ds_read_b128 v[8:11], v212 offset:1024
    ds_read_b128 v[12:15], v213 offset:5120
    ds_read_b128 v[16:19], v213 offset:6144
    ds_read_b128 v[20:23], v214 offset:10240
    ds_read_b128 v[24:27], v214 offset:11264
    s_waitcnt lgkmcnt(6)
    v_lshlrev_b32 v156, 16, v86
    v_and_b32 v157, 0xffff0000, v86
    v_lshlrev_b32 v158, 16, v87
    v_and_b32 v159, 0xffff0000, v87
    v_lshlrev_b32 v160, 16, v88
    v_and_b32 v161, 0xffff0000, v88
    v_lshlrev_b32 v162, 16, v89
    v_and_b32 v163, 0xffff0000, v89
    v_pk_mul_f32 v[156:157], v[84:85], v[156:157] op_sel_hi:[0,1]
    v_pk_mul_f32 v[158:159], v[84:85], v[158:159] op_sel_hi:[0,1]
pad_fin_2:
    s_cbranch_execz pad_fin_3
    v_pk_mul_f32 v[160:161], v[84:85], v[160:161] op_sel_hi:[0,1]
    v_pk_mul_f32 v[162:163], v[84:85], v[162:163] op_sel_hi:[0,1]
    v_sub_f32 v84, 1.0, v84
    v_pk_fma_f32 v[156:157], v[84:85], v[64:65], v[156:157] op_sel_hi:[0,1,1]
    v_pk_fma_f32 v[158:159], v[84:85], v[66:67], v[158:159] op_sel_hi:[0,1,1]
    v_pk_fma_f32 v[160:161], v[84:85], v[68:69], v[160:161] op_sel_hi:[0,1,1]
    v_pk_fma_f32 v[162:163], v[84:85], v[70:71], v[162:163] op_sel_hi:[0,1,1]
    s_waitcnt lgkmcnt(0)
    v_pk_fma_f32 v[156:157], v[84:85], v[4:5], v[156:157] op_sel_hi:[0,1,1]
    v_pk_fma_f32 v[158:159], v[84:85], v[6:7], v[158:159] op_sel_hi:[0,1,1]
    v_pk_fma_f32 v[160:161], v[84:85], v[8:9], v[160:161] op_sel_hi:[0,1,1]
    v_pk_fma_f32 v[162:163], v[84:85], v[10:11], v[162:163] op_sel_hi:[0,1,1]
    v_pk_fma_f32 v[156:157], v[84:85], v[12:13], v[156:157] op_sel_hi:[0,1,1]
    v_pk_fma_f32 v[158:159], v[84:85], v[14:15], v[158:159] op_sel_hi:[0,1,1]
    v_pk_fma_f32 v[160:161], v[84:85], v[16:17], v[160:161] op_sel_hi:[0,1,1]
    v_pk_fma_f32 v[162:163], v[84:85], v[18:19], v[162:163] op_sel_hi:[0,1,1]
pad_fin_3:
    s_cbranch_execz pad_fin_4
    v_pk_fma_f32 v[156:157], v[84:85], v[20:21], v[156:157] op_sel_hi:[0,1,1]
    v_pk_fma_f32 v[158:159], v[84:85], v[22:23], v[158:159] op_sel_hi:[0,1,1]
    v_pk_fma_f32 v[160:161], v[84:85], v[24:25], v[160:161] op_sel_hi:[0,1,1]
    v_pk_fma_f32 v[162:163], v[84:85], v[26:27], v[162:163] op_sel_hi:[0,1,1]
    v_cvt_pk_bf16_f32 v116, v156, v157
    v_cvt_pk_bf16_f32 v117, v158, v159
    v_cvt_pk_bf16_f32 v118, v160, v161
    v_cvt_pk_bf16_f32 v119, v162, v163
    buffer_store_dwordx4 v[116:119], v216, s[64:67], 0 offen offset:0 nt
    s_branch fin_done
fin_mate:
    ds_read_b32 v84, v218
    ds_read_b64_tr_b16 v[90:91], v215 offset:4608
    ds_read_b64_tr_b16 v[92:93], v215 offset:5184
    ds_read_b64_tr_b16 v[94:95], v217 offset:9216
    ds_read_b128 v[4:7], v212 offset:2048
    ds_read_b128 v[8:11], v212 offset:3072
pad_fin_4:
    s_cbranch_execz pad_fin_5
    ds_read_b128 v[12:15], v213 offset:7168
    ds_read_b128 v[16:19], v213 offset:8192
    ds_read_b128 v[20:23], v214 offset:12288
    ds_read_b128 v[24:27], v214 offset:13312
    ds_read_b128 v[28:31], v3 offset:17408
    ds_read_b128 v[32:35], v3 offset:18432
    ds_read_b128 v[36:39], v212 offset:4096
    ds_read_b128 v[40:43], v213 offset:9216
    ds_read_b128 v[44:47], v214 offset:14336
    ds_read_b128 v[48:51], v3 offset:19456
    s_waitcnt lgkmcnt(12)
    v_lshlrev_b32 v164, 16, v90
    v_and_b32 v165, 0xffff0000, v90
    v_lshlrev_b32 v166, 16, v91
    v_and_b32 v167, 0xffff0000, v91
    v_lshlrev_b32 v168, 16, v92
    v_and_b32 v169, 0xffff0000, v92
    v_lshlrev_b32 v170, 16, v93
pad_fin_5:
    s_cbranch_execz pad_fin_6
    v_and_b32 v171, 0xffff0000, v93
    v_lshlrev_b32 v172, 16, v94
    v_and_b32 v173, 0xffff0000, v94
    v_lshlrev_b32 v174, 16, v95
    v_and_b32 v175, 0xffff0000, v95
    v_pk_mul_f32 v[164:165], v[84:85], v[164:165] op_sel_hi:[0,1]
    v_pk_mul_f32 v[166:167], v[84:85], v[166:167] op_sel_hi:[0,1]
    v_pk_mul_f32 v[168:169], v[84:85], v[168:169] op_sel_hi:[0,1]
    v_pk_mul_f32 v[170:171], v[84:85], v[170:171] op_sel_hi:[0,1]
    v_pk_mul_f32 v[172:173], v[84:85], v[172:173] op_sel_hi:[0,1]
    v_pk_mul_f32 v[174:175], v[84:85], v[174:175] op_sel_hi:[0,1]
    v_sub_f32 v84, 1.0, v84
    s_waitcnt lgkmcnt(4)
    v_pk_fma_f32 v[164:165], v[84:85], v[4:5], v[164:165] op_sel_hi:[0,1,1]
    v_pk_fma_f32 v[166:167], v[84:85], v[6:7], v[166:167] op_sel_hi:[0,1,1]
    v_pk_fma_f32 v[168:169], v[84:85], v[8:9], v[168:169] op_sel_hi:[0,1,1]
    v_pk_fma_f32 v[170:171], v[84:85], v[10:11], v[170:171] op_sel_hi:[0,1,1]
    v_pk_fma_f32 v[164:165], v[84:85], v[12:13], v[164:165] op_sel_hi:[0,1,1]
pad_fin_6:
    s_cbranch_execz pad_fin_7
    v_pk_fma_f32 v[166:167], v[84:85], v[14:15], v[166:167] op_sel_hi:[0,1,1]
    v_pk_fma_f32 v[168:169], v[84:85], v[16:17], v[168:169] op_sel_hi:[0,1,1]
    v_pk_fma_f32 v[170:171], v[84:85], v[18:19], v[170:171] op_sel_hi:[0,1,1]
    v_pk_fma_f32 v[164:165], v[84:85], v[20:21], v[164:165] op_sel_hi:[0,1,1]
    v_pk_fma_f32 v[166:167], v[84:85], v[22:23], v[166:167] op_sel_hi:[0,1,1]
    v_pk_fma_f32 v[168:169], v[84:85], v[24:25], v[168:169] op_sel_hi:[0,1,1]
    v_pk_fma_f32 v[170:171], v[84:85], v[26:27], v[170:171] op_sel_hi:[0,1,1]
    v_pk_fma_f32 v[164:165], v[84:85], v[28:29], v[164:165] op_sel_hi:[0,1,1]
    v_pk_fma_f32 v[166:167], v[84:85], v[30:31], v[166:167] op_sel_hi:[0,1,1]
    v_pk_fma_f32 v[168:169], v[84:85], v[32:33], v[168:169] op_sel_hi:[0,1,1]
    v_pk_fma_f32 v[170:171], v[84:85], v[34:35], v[170:171] op_sel_hi:[0,1,1]
    v_cvt_pk_bf16_f32 v120, v164, v165
    v_cvt_pk_bf16_f32 v121, v166, v167
    v_cvt_pk_bf16_f32 v122, v168, v169
    v_cvt_pk_bf16_f32 v123, v170, v171
pad_fin_7:
    s_cbranch_execz lw_done
    buffer_store_dwordx4 v[120:123], v216, s[64:67], 0 offen offset:64 nt
    s_waitcnt lgkmcnt(0)
    v_pk_fma_f32 v[172:173], v[84:85], v[36:37], v[172:173] op_sel_hi:[0,1,1]
    v_pk_fma_f32 v[174:175], v[84:85], v[38:39], v[174:175] op_sel_hi:[0,1,1]
    v_pk_fma_f32 v[172:173], v[84:85], v[40:41], v[172:173] op_sel_hi:[0,1,1]
    v_pk_fma_f32 v[174:175], v[84:85], v[42:43], v[174:175] op_sel_hi:[0,1,1]
    v_pk_fma_f32 v[172:173], v[84:85], v[44:45], v[172:173] op_sel_hi:[0,1,1]
    v_pk_fma_f32 v[174:175], v[84:85], v[46:47], v[174:175] op_sel_hi:[0,1,1]
    v_pk_fma_f32 v[172:173], v[84:85], v[48:49], v[172:173] op_sel_hi:[0,1,1]
    v_pk_fma_f32 v[174:175], v[84:85], v[50:51], v[174:175] op_sel_hi:[0,1,1]
    v_cvt_pk_bf16_f32 v124, v172, v173
    v_cvt_pk_bf16_f32 v125, v174, v175
    buffer_store_dwordx2 v[124:125], v224, s[64:67], 0 offen offset:128 nt
fin_done:
x_end:
the_end:
    s_endpgm
.section .rodata,"a"
.p2align 6
.amdhsa_kernel gated_mix__ssm_conv_s4__glu_gated_bilinear__prompt_kernel
  .amdhsa_next_free_vgpr 256
  .amdhsa_next_free_sgpr 102
  .amdhsa_accum_offset 256
  .amdhsa_group_segment_fixed_size 0
  .amdhsa_kernarg_size 136
  .amdhsa_user_sgpr_count 2
  .amdhsa_user_sgpr_kernarg_segment_ptr 1
  .amdhsa_system_sgpr_workgroup_id_x 1
.end_amdhsa_kernel
```
